```python
import torch

def _softmax(x, axis=-1):
    return torch.softmax(x, dim=axis)
def _gelu(x):
    return torch.nn.functional.gelu(x, approximate="tanh")
def _silu(x):
    return torch.nn.functional.silu(x)
def _sigmoid(x):
    return torch.sigmoid(x)
def _layernorm(x, axis=-1, eps=1e-5):
    m = x.mean(dim=axis, keepdim=True)
    v = x.var(dim=axis, keepdim=True, unbiased=False)
    return (x - m) / torch.sqrt(v + eps)
def _scatter_add(tgt, idx, src, axis=0):
    return tgt.clone().index_add_(axis, idx, src)
def _segment_sum(src, seg, n):
    out = torch.zeros((n,) + src.shape[1:], dtype=src.dtype)
    return out.index_add_(0, seg, src)
def _pad(x, pw):
    flat = tuple(v for pair in reversed(pw) for v in pair)
    return torch.nn.functional.pad(x, flat)

kernel_name = 'gated_mix__ssm_conv_s4d__dense_activation_squared_relu__prompt'

def setup_inputs():

    _w = (lambda a: (lambda t: t.to(torch.bfloat16) if t.is_floating_point() else t)(torch.as_tensor(a)))
    def _A_setup():
        Bsz, L, D, N = 1, 2048, 512, 128
        return {
            "u": _w((lambda *s: torch.randn(*s, dtype=torch.bfloat16) * 0.05)(Bsz, L, D)),
            "log_A_real": _w((lambda *s: torch.randn(*s, dtype=torch.bfloat16) * 6.4)(D, N) * 0.5),
            "A_imag": _w((lambda *s: torch.randn(*s, dtype=torch.bfloat16) * 0.1)(D, N) * 3.14),
            "C_real": _w((lambda *s: torch.randn(*s, dtype=torch.bfloat16) * 0.4)(D, N) / N ** 0.5),
            "C_imag": _w((lambda *s: torch.randn(*s, dtype=torch.bfloat16) * 0.4)(D, N) / N ** 0.5),
            "log_dt": _w((lambda *s: torch.randn(*s, dtype=torch.bfloat16) * 0.1)(D) * 0.5 - 4.0),
            "D_skip": _w((lambda *s: torch.randn(*s, dtype=torch.bfloat16) * 0.1)(D)),
        }
    _A_in = _A_setup()

    def _B_setup():
        B, S, D, F = 1, 2048, 512, 1792
        return {
            "x": _w((lambda *s: torch.randn(*s, dtype=torch.bfloat16) * 0.05)(B, S, D)),
            "w1": _w((lambda *s: torch.randn(*s, dtype=torch.bfloat16) * 0.05)(D, F)),
            "b1": _w((lambda *s: torch.randn(*s, dtype=torch.bfloat16) * 0.05)(F)),
            "w2": _w((lambda *s: torch.randn(*s, dtype=torch.bfloat16) * 0.05)(F, D)),
            "b2": _w((lambda *s: torch.randn(*s, dtype=torch.bfloat16) * 0.05)(D)),
        }
    _B_in = _B_setup()

    return {
        "A_u": _A_in["u"],
        "A_log_A_real": _A_in["log_A_real"],
        "A_A_imag": _A_in["A_imag"],
        "A_C_real": _A_in["C_real"],
        "A_C_imag": _A_in["C_imag"],
        "A_log_dt": _A_in["log_dt"],
        "A_D_skip": _A_in["D_skip"],
        "B_x": _B_in["x"],
        "B_w1": _B_in["w1"],
        "B_b1": _B_in["b1"],
        "B_w2": _B_in["w2"],
        "B_b2": _B_in["b2"],
        "gate_w": _w((lambda *s: torch.randn(*s, dtype=torch.bfloat16) * 0.05)(512) * 16.0),
    }

def reference(A_u, A_log_A_real, A_A_imag, A_C_real, A_C_imag, A_log_dt, A_D_skip, B_x, B_w1, B_b1, B_w2, B_b2, gate_w):
    def _A_ref(u, log_A_real, A_imag, C_real, C_imag, log_dt, D_skip):
        L = u.shape[1]
        dt = torch.exp(log_dt)
        A = -torch.exp(log_A_real) + 1j * A_imag
        C = (C_real + 1j * C_imag) * dt[:, None]
        pos = (lambda x, dt: x.to(dt))(torch.arange(L), log_dt.dtype)
        P = torch.exp((A * dt[:, None])[:, :, None] * pos[None, None, :])
        K = 2.0 * torch.einsum("dn,dnl->dl", C, P).real
        L2 = 2 * L
        u_t = (lambda x, *d: x.permute(*d))(u, 0, 2, 1)
        Kf = (lambda x, *a, **k: torch.fft.rfft(x.float(), *a, **k))(K, L2)
        Uf = (lambda x, *a, **k: torch.fft.rfft(x.float(), *a, **k))(u_t, L2)
        y = (lambda x, *a, **k: torch.fft.irfft(x, *a, **k).to(torch.bfloat16))(Uf * Kf[None, :, :], L2)[:, :, :L]
        y = (lambda x, *d: x.permute(*d))(y, 0, 2, 1)
        return y + u * D_skip[None, None, :]

    def _B_ref(x, w1, b1, w2, b2):
        h = torch.einsum("bsd,df->bsf", x, w1) + b1
        zero = torch.zeros_like(h)
        r = torch.where(h > zero, h, zero)
        h = r * r
        out = torch.einsum("bsf,fd->bsd", h, w2) + b2
        return out

    x = A_u
    g = _sigmoid((x * gate_w).sum(-1, keepdims=True))
    a = _A_ref(x, A_log_A_real, A_A_imag, A_C_real, A_C_imag, A_log_dt, A_D_skip)
    b = _B_ref(x, B_w1, B_b1, B_w2, B_b2)
    return g * a + (1 - g) * b
```

```asm
; @launch grid=(256,1,1) block=(512,1,1) lds=163840
.amdgcn_target "amdgcn-amd-amdhsa--gfx950"
.text
.globl gated_mix__ssm_conv_s4d__dense_activation_squared_relu__prompt_kernel
.p2align 8
.type gated_mix__ssm_conv_s4d__dense_activation_squared_relu__prompt_kernel,@function
gated_mix__ssm_conv_s4d__dense_activation_squared_relu__prompt_kernel:
    s_cmp_ge_u32 s2, 256
    s_cbranch_scc1 La_exit
    s_load_dwordx16 s[16:31], s[0:1], 0
    s_load_dwordx16 s[32:47], s[0:1], 64
    v_lshrrev_b32 v2, 6, v0
    v_and_b32 v1, 63, v0
    v_readfirstlane_b32 s3, v2
    s_and_b32 s4, s2, 7
    s_lshr_b32 s5, s2, 3
    s_lshl_b32 s97, s5, 1
    s_lshr_b32 s6, s5, 4
    s_or_b32 s97, s97, s6
    s_and_b32 s97, s97, 31
    s_lshl_b32 s97, s97, 3
    s_cmp_ge_u32 s5, 30
    s_cbranch_scc1 La_idle
    s_cmp_ge_u32 s5, 14
    s_cbranch_scc1 La_conv
    s_xor_b32 s5, s5, 1
    s_lshl_b32 s8, s5, 8
    s_cmp_lt_u32 s3, 4
    s_cbranch_scc1 Lg_comp
    s_sub_u32 s11, s3, 4
    s_lshl_b32 s6, s4, 18
    s_lshl_b32 s7, s11, 16
    v_lshrrev_b32 v5, 3, v1
    v_lshrrev_b32 v6, 4, v1
    v_and_b32 v7, 7, v1
    v_xor_b32 v7, v7, v6
    v_lshlrev_b32 v7, 4, v7
    v_lshl_add_u32 v2, v5, 10, v7
    v_add_u32 v2, s7, v2
    v_xor_b32 v3, 64, v2
    v_add_u32 v3, 0x2000, v3
    s_mul_i32 s7, s11, 57344
    s_add_u32 s7, s7, s8
    v_and_b32 v7, 15, v1
    v_lshlrev_b32 v5, 2, v6
    v_xor_b32 v7, v7, v5
    v_lshlrev_b32 v7, 4, v7
    v_mul_u32_u24 v5, 3584, v6
    v_add3_u32 v4, v5, v7, s7
    s_lshl_b32 s9, s11, 13
    s_lshl_b32 s10, s11, 12
    s_add_u32 s10, s10, 32768
    s_add_u32 s12, s4, s5
    s_waitcnt lgkmcnt(0)
    s_add_u32 s48, s16, s6
    s_addc_u32 s49, s17, 0
    s_mov_b32 s50, 262144
    s_mov_b32 s51, 0x20000
    s_mov_b32 s52, s32
    s_mov_b32 s53, s33
    s_mov_b32 s54, 1835008
    s_mov_b32 s55, 0x20000
    s_and_b32 s12, s12, 7
    s_lshl_b32 s14, s12, 7
    s_add_u32 m0, s10, 0
    s_mul_i32 s64, s12, 229376
    buffer_load_dwordx4 v4, s[52:55], s64 offen lds
    s_add_u32 m0, m0, 1024
    s_add_u32 s64, s64, 14336
    buffer_load_dwordx4 v4, s[52:55], s64 offen lds
    s_add_u32 m0, m0, 1024
    s_add_u32 s64, s64, 14336
    buffer_load_dwordx4 v4, s[52:55], s64 offen lds
    s_add_u32 m0, m0, 1024
    s_add_u32 s64, s64, 14336
    buffer_load_dwordx4 v4, s[52:55], s64 offen lds
    s_add_u32 m0, s9, 0
    s_add_u32 s12, s12, 1
    buffer_load_dwordx4 v2, s[48:51], s14 offen lds
    s_add_u32 m0, m0, 1024
    s_nop 0
    buffer_load_dwordx4 v3, s[48:51], s14 offen lds
    s_add_u32 m0, m0, 1024
    s_add_u32 s14, s14, 16384
    buffer_load_dwordx4 v2, s[48:51], s14 offen lds
    s_add_u32 m0, m0, 1024
    s_nop 0
    buffer_load_dwordx4 v3, s[48:51], s14 offen lds
    s_add_u32 m0, m0, 1024
    s_add_u32 s14, s14, 16384
    buffer_load_dwordx4 v2, s[48:51], s14 offen lds
    s_add_u32 m0, m0, 1024
    s_nop 0
    buffer_load_dwordx4 v3, s[48:51], s14 offen lds
    s_add_u32 m0, m0, 1024
    s_add_u32 s14, s14, 16384
    buffer_load_dwordx4 v2, s[48:51], s14 offen lds
    s_add_u32 m0, m0, 1024
    s_nop 0
    buffer_load_dwordx4 v3, s[48:51], s14 offen lds
    s_and_b32 s12, s12, 7
    s_lshl_b32 s14, s12, 7
    s_add_u32 m0, s10, 49152
    s_mul_i32 s64, s12, 229376
    buffer_load_dwordx4 v4, s[52:55], s64 offen lds
    s_add_u32 m0, m0, 1024
    s_add_u32 s64, s64, 14336
    buffer_load_dwordx4 v4, s[52:55], s64 offen lds
    s_add_u32 m0, m0, 1024
    s_add_u32 s64, s64, 14336
    buffer_load_dwordx4 v4, s[52:55], s64 offen lds
    s_add_u32 m0, m0, 1024
    s_add_u32 s64, s64, 14336
    buffer_load_dwordx4 v4, s[52:55], s64 offen lds
    s_add_u32 m0, s9, 49152
    s_add_u32 s12, s12, 1
    buffer_load_dwordx4 v2, s[48:51], s14 offen lds
    s_add_u32 m0, m0, 1024
    s_nop 0
    buffer_load_dwordx4 v3, s[48:51], s14 offen lds
    s_add_u32 m0, m0, 1024
    s_add_u32 s14, s14, 16384
    buffer_load_dwordx4 v2, s[48:51], s14 offen lds
    s_add_u32 m0, m0, 1024
    s_nop 0
    buffer_load_dwordx4 v3, s[48:51], s14 offen lds
    s_add_u32 m0, m0, 1024
    s_add_u32 s14, s14, 16384
    buffer_load_dwordx4 v2, s[48:51], s14 offen lds
    s_add_u32 m0, m0, 1024
    s_nop 0
    buffer_load_dwordx4 v3, s[48:51], s14 offen lds
    s_add_u32 m0, m0, 1024
    s_add_u32 s14, s14, 16384
    buffer_load_dwordx4 v2, s[48:51], s14 offen lds
    s_add_u32 m0, m0, 1024
    s_nop 0
    buffer_load_dwordx4 v3, s[48:51], s14 offen lds
    s_sub_u32 s77, s3, 4
    s_bfe_u32 s76, s97, 0x30003
    s_mul_i32 s91, s77, 458752
    s_lshl_b32 s80, s76, 7
    s_add_u32 s91, s91, s80
    v_lshrrev_b32 v44, 3, v1
    v_lshlrev_b32 v44, 10, v44
    v_bfe_u32 v45, v1, 4, 1
    v_lshlrev_b32 v45, 2, v45
    v_and_b32 v5, 7, v1
    v_xor_b32 v45, v45, v5
    v_lshl_add_u32 v44, v45, 4, v44
    v_add_u32 v44, s91, v44
    v_add_u32 v45, 0x2000, v44
    s_lshr_b32 s80, s97, 6
    s_lshl_b32 s80, s80, 1
    s_add_u32 s80, s80, s76
    s_cmp_ge_u32 s80, 7
    s_cselect_b32 s81, 7, 0
    s_sub_u32 s80, s80, s81
    s_lshl_b32 s80, s80, 12
    s_add_u32 s81, s80, 4096
    s_cmp_eq_u32 s81, 28672
    s_cselect_b32 s81, 0, s81
    s_add_u32 s82, s81, 4096
    s_cmp_eq_u32 s82, 28672
    s_cselect_b32 s82, 0, s82
    s_add_u32 s83, s82, 4096
    s_cmp_eq_u32 s83, 28672
    s_cselect_b32 s83, 0, s83
    s_add_u32 s84, s83, 4096
    s_cmp_eq_u32 s84, 28672
    s_cselect_b32 s84, 0, s84
    s_add_u32 s85, s84, 4096
    s_cmp_eq_u32 s85, 28672
    s_cselect_b32 s85, 0, s85
    s_add_u32 s86, s85, 4096
    s_cmp_eq_u32 s86, 28672
    s_cselect_b32 s86, 0, s86
    s_lshr_b32 s76, s77, 1
    v_bfe_u32 v43, v1, 2, 2
    v_lshrrev_b32 v5, 5, v1
    v_lshl_add_u32 v43, v5, 2, v43
    v_lshlrev_b32 v43, 7, v43
    v_bfe_u32 v5, v1, 3, 1
    v_xor_b32 v5, s76, v5
    v_lshl_add_u32 v43, v5, 6, v43
    v_bfe_u32 v5, v1, 4, 1
    v_lshl_add_u32 v43, v5, 5, v43
    v_and_b32 v5, 3, v1
    v_lshl_add_u32 v43, v5, 3, v43
    s_mul_i32 s90, s77, 40960
    s_add_u32 s87, s90, 8704
    s_add_u32 s88, s90, 29184
    s_mul_i32 s78, s77, 12288
    s_add_u32 s78, s78, 98304
    s_lshl_b32 s89, s77, 12
    s_add_u32 s89, s89, 147456
    s_mov_b32 s92, s36
    s_mov_b32 s93, s37
    s_mov_b32 s94, 1835008
    s_mov_b32 s95, 0x20000
    s_waitcnt vmcnt(12)
    s_barrier
    s_and_b32 s12, s12, 7
    s_lshl_b32 s14, s12, 7
    s_add_u32 m0, s10, 98304
    s_mul_i32 s64, s12, 229376
    buffer_load_dwordx4 v4, s[52:55], s64 offen lds
    s_add_u32 m0, m0, 1024
    s_add_u32 s64, s64, 14336
    buffer_load_dwordx4 v4, s[52:55], s64 offen lds
    s_add_u32 m0, m0, 1024
    s_add_u32 s64, s64, 14336
    buffer_load_dwordx4 v4, s[52:55], s64 offen lds
    s_add_u32 m0, m0, 1024
    s_add_u32 s64, s64, 14336
    buffer_load_dwordx4 v4, s[52:55], s64 offen lds
    s_add_u32 m0, s9, 98304
    s_add_u32 s12, s12, 1
    buffer_load_dwordx4 v2, s[48:51], s14 offen lds
    s_add_u32 m0, m0, 1024
    s_nop 0
    buffer_load_dwordx4 v3, s[48:51], s14 offen lds
    s_add_u32 m0, m0, 1024
    s_add_u32 s14, s14, 16384
    buffer_load_dwordx4 v2, s[48:51], s14 offen lds
    s_add_u32 m0, m0, 1024
    s_nop 0
    buffer_load_dwordx4 v3, s[48:51], s14 offen lds
    s_add_u32 m0, m0, 1024
    s_add_u32 s14, s14, 16384
    buffer_load_dwordx4 v2, s[48:51], s14 offen lds
    s_add_u32 m0, m0, 1024
    s_nop 0
    buffer_load_dwordx4 v3, s[48:51], s14 offen lds
    s_add_u32 m0, m0, 1024
    s_add_u32 s14, s14, 16384
    buffer_load_dwordx4 v2, s[48:51], s14 offen lds
    s_add_u32 m0, m0, 1024
    s_nop 0
    buffer_load_dwordx4 v3, s[48:51], s14 offen lds
    s_add_u32 m0, s89, 0
    s_lshl_b32 s91, s80, 4
    buffer_load_dwordx4 v44, s[92:95], s91 offen lds
    s_add_u32 m0, m0, 1024
    s_nop 0
    buffer_load_dwordx4 v45, s[92:95], s91 offen lds
    s_waitcnt vmcnt(14)
    s_barrier
    s_and_b32 s12, s12, 7
    s_lshl_b32 s14, s12, 7
    s_add_u32 m0, s10, 0
    s_mul_i32 s64, s12, 229376
    buffer_load_dwordx4 v4, s[52:55], s64 offen lds
    s_add_u32 m0, m0, 1024
    s_add_u32 s64, s64, 14336
    buffer_load_dwordx4 v4, s[52:55], s64 offen lds
    s_add_u32 m0, m0, 1024
    s_add_u32 s64, s64, 14336
    buffer_load_dwordx4 v4, s[52:55], s64 offen lds
    s_add_u32 m0, m0, 1024
    s_add_u32 s64, s64, 14336
    buffer_load_dwordx4 v4, s[52:55], s64 offen lds
    s_add_u32 m0, s9, 0
    s_add_u32 s12, s12, 1
    buffer_load_dwordx4 v2, s[48:51], s14 offen lds
    s_add_u32 m0, m0, 1024
    s_nop 0
    buffer_load_dwordx4 v3, s[48:51], s14 offen lds
    s_add_u32 m0, m0, 1024
    s_add_u32 s14, s14, 16384
    buffer_load_dwordx4 v2, s[48:51], s14 offen lds
    s_add_u32 m0, m0, 1024
    s_nop 0
    buffer_load_dwordx4 v3, s[48:51], s14 offen lds
    s_add_u32 m0, m0, 1024
    s_add_u32 s14, s14, 16384
    buffer_load_dwordx4 v2, s[48:51], s14 offen lds
    s_add_u32 m0, m0, 1024
    s_nop 0
    buffer_load_dwordx4 v3, s[48:51], s14 offen lds
    s_add_u32 m0, m0, 1024
    s_add_u32 s14, s14, 16384
    buffer_load_dwordx4 v2, s[48:51], s14 offen lds
    s_add_u32 m0, m0, 1024
    s_nop 0
    buffer_load_dwordx4 v3, s[48:51], s14 offen lds
    s_add_u32 m0, s89, 2048
    s_lshl_b32 s91, s80, 4
    s_add_u32 s91, s91, 16384
    buffer_load_dwordx4 v44, s[92:95], s91 offen lds
    s_add_u32 m0, m0, 1024
    s_nop 0
    buffer_load_dwordx4 v45, s[92:95], s91 offen lds
    s_waitcnt vmcnt(16)
    s_barrier
    s_and_b32 s12, s12, 7
    s_lshl_b32 s14, s12, 7
    s_add_u32 m0, s10, 49152
    s_mul_i32 s64, s12, 229376
    buffer_load_dwordx4 v4, s[52:55], s64 offen lds
    s_add_u32 m0, m0, 1024
    s_add_u32 s64, s64, 14336
    buffer_load_dwordx4 v4, s[52:55], s64 offen lds
    s_add_u32 m0, m0, 1024
    s_add_u32 s64, s64, 14336
    buffer_load_dwordx4 v4, s[52:55], s64 offen lds
    s_add_u32 m0, m0, 1024
    s_add_u32 s64, s64, 14336
    buffer_load_dwordx4 v4, s[52:55], s64 offen lds
    s_add_u32 m0, s9, 49152
    s_add_u32 s12, s12, 1
    buffer_load_dwordx4 v2, s[48:51], s14 offen lds
    s_add_u32 m0, m0, 1024
    s_nop 0
    buffer_load_dwordx4 v3, s[48:51], s14 offen lds
    s_add_u32 m0, m0, 1024
    s_add_u32 s14, s14, 16384
    buffer_load_dwordx4 v2, s[48:51], s14 offen lds
    s_add_u32 m0, m0, 1024
    s_nop 0
    buffer_load_dwordx4 v3, s[48:51], s14 offen lds
    s_add_u32 m0, m0, 1024
    s_add_u32 s14, s14, 16384
    buffer_load_dwordx4 v2, s[48:51], s14 offen lds
    s_add_u32 m0, m0, 1024
    s_nop 0
    buffer_load_dwordx4 v3, s[48:51], s14 offen lds
    s_add_u32 m0, m0, 1024
    s_add_u32 s14, s14, 16384
    buffer_load_dwordx4 v2, s[48:51], s14 offen lds
    s_add_u32 m0, m0, 1024
    s_nop 0
    buffer_load_dwordx4 v3, s[48:51], s14 offen lds
    s_waitcnt vmcnt(26)
    v_add_u32 v240, s89, v43
    v_xor_b32 v241, 64, v240
    ds_read_b64_tr_b16 v[128:129], v240 offset:0
    ds_read_b64_tr_b16 v[130:131], v240 offset:1024
    ds_read_b64_tr_b16 v[132:133], v241 offset:0
    ds_read_b64_tr_b16 v[134:135], v241 offset:1024
    s_waitcnt lgkmcnt(0)
    s_add_u32 m0, s89, 0
    s_lshl_b32 s91, s80, 4
    s_add_u32 s91, s91, 32768
    buffer_load_dwordx4 v44, s[92:95], s91 offen lds
    s_add_u32 m0, m0, 1024
    s_nop 0
    buffer_load_dwordx4 v45, s[92:95], s91 offen lds
    s_waitcnt vmcnt(16)
    s_barrier
    s_and_b32 s12, s12, 7
    s_lshl_b32 s14, s12, 7
    s_add_u32 m0, s10, 98304
    s_mul_i32 s64, s12, 229376
    buffer_load_dwordx4 v4, s[52:55], s64 offen lds
    s_add_u32 m0, m0, 1024
    s_add_u32 s64, s64, 14336
    buffer_load_dwordx4 v4, s[52:55], s64 offen lds
    s_add_u32 m0, m0, 1024
    s_add_u32 s64, s64, 14336
    buffer_load_dwordx4 v4, s[52:55], s64 offen lds
    s_add_u32 m0, m0, 1024
    s_add_u32 s64, s64, 14336
    buffer_load_dwordx4 v4, s[52:55], s64 offen lds
    s_add_u32 m0, s9, 98304
    s_add_u32 s12, s12, 1
    buffer_load_dwordx4 v2, s[48:51], s14 offen lds
    s_add_u32 m0, m0, 1024
    s_nop 0
    buffer_load_dwordx4 v3, s[48:51], s14 offen lds
    s_add_u32 m0, m0, 1024
    s_add_u32 s14, s14, 16384
    buffer_load_dwordx4 v2, s[48:51], s14 offen lds
    s_add_u32 m0, m0, 1024
    s_nop 0
    buffer_load_dwordx4 v3, s[48:51], s14 offen lds
    s_add_u32 m0, m0, 1024
    s_add_u32 s14, s14, 16384
    buffer_load_dwordx4 v2, s[48:51], s14 offen lds
    s_add_u32 m0, m0, 1024
    s_nop 0
    buffer_load_dwordx4 v3, s[48:51], s14 offen lds
    s_add_u32 m0, m0, 1024
    s_add_u32 s14, s14, 16384
    buffer_load_dwordx4 v2, s[48:51], s14 offen lds
    s_add_u32 m0, m0, 1024
    s_nop 0
    buffer_load_dwordx4 v3, s[48:51], s14 offen lds
    s_waitcnt vmcnt(26)
    v_add_u32 v240, s89, v43
    v_xor_b32 v241, 64, v240
    ds_read_b64_tr_b16 v[136:137], v240 offset:2048
    ds_read_b64_tr_b16 v[138:139], v240 offset:3072
    ds_read_b64_tr_b16 v[140:141], v241 offset:2048
    ds_read_b64_tr_b16 v[142:143], v241 offset:3072
    s_waitcnt lgkmcnt(0)
    s_add_u32 m0, s89, 2048
    s_lshl_b32 s91, s80, 4
    s_add_u32 s91, s91, 49152
    buffer_load_dwordx4 v44, s[92:95], s91 offen lds
    s_add_u32 m0, m0, 1024
    s_nop 0
    buffer_load_dwordx4 v45, s[92:95], s91 offen lds
    s_waitcnt vmcnt(16)
    s_barrier
    s_and_b32 s12, s12, 7
    s_lshl_b32 s14, s12, 7
    s_add_u32 m0, s10, 0
    s_mul_i32 s64, s12, 229376
    buffer_load_dwordx4 v4, s[52:55], s64 offen lds
    s_add_u32 m0, m0, 1024
    s_add_u32 s64, s64, 14336
    buffer_load_dwordx4 v4, s[52:55], s64 offen lds
    s_add_u32 m0, m0, 1024
    s_add_u32 s64, s64, 14336
    buffer_load_dwordx4 v4, s[52:55], s64 offen lds
    s_add_u32 m0, m0, 1024
    s_add_u32 s64, s64, 14336
    buffer_load_dwordx4 v4, s[52:55], s64 offen lds
    s_add_u32 m0, s9, 0
    s_add_u32 s12, s12, 1
    buffer_load_dwordx4 v2, s[48:51], s14 offen lds
    s_add_u32 m0, m0, 1024
    s_nop 0
    buffer_load_dwordx4 v3, s[48:51], s14 offen lds
    s_add_u32 m0, m0, 1024
    s_add_u32 s14, s14, 16384
    buffer_load_dwordx4 v2, s[48:51], s14 offen lds
    s_add_u32 m0, m0, 1024
    s_nop 0
    buffer_load_dwordx4 v3, s[48:51], s14 offen lds
    s_add_u32 m0, m0, 1024
    s_add_u32 s14, s14, 16384
    buffer_load_dwordx4 v2, s[48:51], s14 offen lds
    s_add_u32 m0, m0, 1024
    s_nop 0
    buffer_load_dwordx4 v3, s[48:51], s14 offen lds
    s_add_u32 m0, m0, 1024
    s_add_u32 s14, s14, 16384
    buffer_load_dwordx4 v2, s[48:51], s14 offen lds
    s_add_u32 m0, m0, 1024
    s_nop 0
    buffer_load_dwordx4 v3, s[48:51], s14 offen lds
    s_waitcnt vmcnt(26)
    v_add_u32 v240, s89, v43
    v_xor_b32 v241, 64, v240
    ds_read_b64_tr_b16 v[144:145], v240 offset:0
    ds_read_b64_tr_b16 v[146:147], v240 offset:1024
    ds_read_b64_tr_b16 v[148:149], v241 offset:0
    ds_read_b64_tr_b16 v[150:151], v241 offset:1024
    s_waitcnt lgkmcnt(0)
    s_add_u32 m0, s89, 0
    s_lshl_b32 s91, s81, 4
    buffer_load_dwordx4 v44, s[92:95], s91 offen lds
    s_add_u32 m0, m0, 1024
    s_nop 0
    buffer_load_dwordx4 v45, s[92:95], s91 offen lds
    s_waitcnt vmcnt(16)
    s_barrier
    s_and_b32 s12, s12, 7
    s_lshl_b32 s14, s12, 7
    s_add_u32 m0, s10, 49152
    s_mul_i32 s64, s12, 229376
    buffer_load_dwordx4 v4, s[52:55], s64 offen lds
    s_add_u32 m0, m0, 1024
    s_add_u32 s64, s64, 14336
    buffer_load_dwordx4 v4, s[52:55], s64 offen lds
    s_add_u32 m0, m0, 1024
    s_add_u32 s64, s64, 14336
    buffer_load_dwordx4 v4, s[52:55], s64 offen lds
    s_add_u32 m0, m0, 1024
    s_add_u32 s64, s64, 14336
    buffer_load_dwordx4 v4, s[52:55], s64 offen lds
    s_add_u32 m0, s9, 49152
    s_add_u32 s12, s12, 1
    buffer_load_dwordx4 v2, s[48:51], s14 offen lds
    s_add_u32 m0, m0, 1024
    s_nop 0
    buffer_load_dwordx4 v3, s[48:51], s14 offen lds
    s_add_u32 m0, m0, 1024
    s_add_u32 s14, s14, 16384
    buffer_load_dwordx4 v2, s[48:51], s14 offen lds
    s_add_u32 m0, m0, 1024
    s_nop 0
    buffer_load_dwordx4 v3, s[48:51], s14 offen lds
    s_add_u32 m0, m0, 1024
    s_add_u32 s14, s14, 16384
    buffer_load_dwordx4 v2, s[48:51], s14 offen lds
    s_add_u32 m0, m0, 1024
    s_nop 0
    buffer_load_dwordx4 v3, s[48:51], s14 offen lds
    s_add_u32 m0, m0, 1024
    s_add_u32 s14, s14, 16384
    buffer_load_dwordx4 v2, s[48:51], s14 offen lds
    s_add_u32 m0, m0, 1024
    s_nop 0
    buffer_load_dwordx4 v3, s[48:51], s14 offen lds
    s_waitcnt vmcnt(26)
    v_add_u32 v240, s89, v43
    v_xor_b32 v241, 64, v240
    ds_read_b64_tr_b16 v[152:153], v240 offset:2048
    ds_read_b64_tr_b16 v[154:155], v240 offset:3072
    ds_read_b64_tr_b16 v[156:157], v241 offset:2048
    ds_read_b64_tr_b16 v[158:159], v241 offset:3072
    s_waitcnt lgkmcnt(0)
    s_add_u32 m0, s89, 2048
    s_lshl_b32 s91, s81, 4
    s_add_u32 s91, s91, 16384
    buffer_load_dwordx4 v44, s[92:95], s91 offen lds
    s_add_u32 m0, m0, 1024
    s_nop 0
    buffer_load_dwordx4 v45, s[92:95], s91 offen lds
    s_waitcnt vmcnt(16)
    s_barrier
    s_add_u32 m0, s78, 0
    s_lshl_b32 s91, s82, 4
    buffer_load_dwordx4 v44, s[92:95], s91 offen lds
    s_add_u32 m0, m0, 1024
    s_nop 0
    buffer_load_dwordx4 v45, s[92:95], s91 offen lds
    s_add_u32 m0, s78, 2048
    s_add_u32 s91, s91, 16384
    buffer_load_dwordx4 v44, s[92:95], s91 offen lds
    s_add_u32 m0, m0, 1024
    s_nop 0
    buffer_load_dwordx4 v45, s[92:95], s91 offen lds
    s_add_u32 m0, s78, 4096
    s_add_u32 s91, s91, 16384
    buffer_load_dwordx4 v44, s[92:95], s91 offen lds
    s_add_u32 m0, m0, 1024
    s_nop 0
    buffer_load_dwordx4 v45, s[92:95], s91 offen lds
    s_add_u32 m0, s78, 6144
    s_add_u32 s91, s91, 16384
    buffer_load_dwordx4 v44, s[92:95], s91 offen lds
    s_add_u32 m0, m0, 1024
    s_nop 0
    buffer_load_dwordx4 v45, s[92:95], s91 offen lds
    s_add_u32 m0, s78, 8192
    s_lshl_b32 s91, s83, 4
    buffer_load_dwordx4 v44, s[92:95], s91 offen lds
    s_add_u32 m0, m0, 1024
    s_nop 0
    buffer_load_dwordx4 v45, s[92:95], s91 offen lds
    s_add_u32 m0, s78, 10240
    s_add_u32 s91, s91, 16384
    buffer_load_dwordx4 v44, s[92:95], s91 offen lds
    s_add_u32 m0, m0, 1024
    s_nop 0
    buffer_load_dwordx4 v45, s[92:95], s91 offen lds
    s_waitcnt vmcnt(12)
    v_add_u32 v240, s89, v43
    v_xor_b32 v241, 64, v240
    ds_read_b64_tr_b16 v[160:161], v240 offset:0
    ds_read_b64_tr_b16 v[162:163], v240 offset:1024
    ds_read_b64_tr_b16 v[164:165], v241 offset:0
    ds_read_b64_tr_b16 v[166:167], v241 offset:1024
    ds_read_b64_tr_b16 v[168:169], v240 offset:2048
    ds_read_b64_tr_b16 v[170:171], v240 offset:3072
    ds_read_b64_tr_b16 v[172:173], v241 offset:2048
    ds_read_b64_tr_b16 v[174:175], v241 offset:3072
    s_barrier
    s_waitcnt lgkmcnt(0)
    s_add_u32 m0, s89, 0
    s_lshl_b32 s91, s81, 4
    s_add_u32 s91, s91, 32768
    buffer_load_dwordx4 v44, s[92:95], s91 offen lds
    s_add_u32 m0, m0, 1024
    s_nop 0
    buffer_load_dwordx4 v45, s[92:95], s91 offen lds
    s_add_u32 m0, s89, 2048
    s_add_u32 s91, s91, 16384
    buffer_load_dwordx4 v44, s[92:95], s91 offen lds
    s_add_u32 m0, m0, 1024
    s_nop 0
    buffer_load_dwordx4 v45, s[92:95], s91 offen lds
    s_waitcnt vmcnt(4)
    v_add_u32 v240, s78, v43
    v_xor_b32 v241, 64, v240
    ds_read_b64_tr_b16 v[192:193], v240 offset:0
    ds_read_b64_tr_b16 v[194:195], v240 offset:1024
    ds_read_b64_tr_b16 v[196:197], v241 offset:0
    ds_read_b64_tr_b16 v[198:199], v241 offset:1024
    ds_read_b64_tr_b16 v[200:201], v240 offset:2048
    ds_read_b64_tr_b16 v[202:203], v240 offset:3072
    ds_read_b64_tr_b16 v[204:205], v241 offset:2048
    ds_read_b64_tr_b16 v[206:207], v241 offset:3072
    ds_read_b64_tr_b16 v[208:209], v240 offset:4096
    ds_read_b64_tr_b16 v[210:211], v240 offset:5120
    ds_read_b64_tr_b16 v[212:213], v241 offset:4096
    ds_read_b64_tr_b16 v[214:215], v241 offset:5120
    ds_read_b64_tr_b16 v[216:217], v240 offset:6144
    ds_read_b64_tr_b16 v[218:219], v240 offset:7168
    ds_read_b64_tr_b16 v[220:221], v241 offset:6144
    ds_read_b64_tr_b16 v[222:223], v241 offset:7168
    ds_read_b64_tr_b16 v[224:225], v240 offset:8192
    ds_read_b64_tr_b16 v[226:227], v240 offset:9216
    ds_read_b64_tr_b16 v[228:229], v241 offset:8192
    ds_read_b64_tr_b16 v[230:231], v241 offset:9216
    ds_read_b64_tr_b16 v[232:233], v240 offset:10240
    ds_read_b64_tr_b16 v[234:235], v240 offset:11264
    ds_read_b64_tr_b16 v[236:237], v241 offset:10240
    ds_read_b64_tr_b16 v[238:239], v241 offset:11264
    s_waitcnt vmcnt(0)
    v_add_u32 v240, s89, v43
    v_xor_b32 v241, 64, v240
    ds_read_b64_tr_b16 v[176:177], v240 offset:0
    ds_read_b64_tr_b16 v[178:179], v240 offset:1024
    ds_read_b64_tr_b16 v[180:181], v241 offset:0
    ds_read_b64_tr_b16 v[182:183], v241 offset:1024
    ds_read_b64_tr_b16 v[184:185], v240 offset:2048
    ds_read_b64_tr_b16 v[186:187], v240 offset:3072
    ds_read_b64_tr_b16 v[188:189], v241 offset:2048
    ds_read_b64_tr_b16 v[190:191], v241 offset:3072
    s_waitcnt lgkmcnt(0)
    s_barrier
    s_add_u32 m0, s87, 0
    s_lshl_b32 s91, s83, 4
    s_add_u32 s91, s91, 32768
    buffer_load_dwordx4 v44, s[92:95], s91 offen lds
    s_add_u32 m0, m0, 1024
    s_nop 0
    buffer_load_dwordx4 v45, s[92:95], s91 offen lds
    s_add_u32 m0, s87, 2048
    s_add_u32 s91, s91, 16384
    buffer_load_dwordx4 v44, s[92:95], s91 offen lds
    s_add_u32 m0, m0, 1024
    s_nop 0
    buffer_load_dwordx4 v45, s[92:95], s91 offen lds
    s_add_u32 m0, s87, 4096
    s_lshl_b32 s91, s84, 4
    buffer_load_dwordx4 v44, s[92:95], s91 offen lds
    s_add_u32 m0, m0, 1024
    s_nop 0
    buffer_load_dwordx4 v45, s[92:95], s91 offen lds
    s_add_u32 m0, s87, 6144
    s_add_u32 s91, s91, 16384
    buffer_load_dwordx4 v44, s[92:95], s91 offen lds
    s_add_u32 m0, m0, 1024
    s_nop 0
    buffer_load_dwordx4 v45, s[92:95], s91 offen lds
    s_add_u32 m0, s87, 8192
    s_add_u32 s91, s91, 16384
    buffer_load_dwordx4 v44, s[92:95], s91 offen lds
    s_add_u32 m0, m0, 1024
    s_nop 0
    buffer_load_dwordx4 v45, s[92:95], s91 offen lds
    s_add_u32 m0, s87, 10240
    s_add_u32 s91, s91, 16384
    buffer_load_dwordx4 v44, s[92:95], s91 offen lds
    s_add_u32 m0, m0, 1024
    s_nop 0
    buffer_load_dwordx4 v45, s[92:95], s91 offen lds
    s_add_u32 m0, s87, 12288
    s_lshl_b32 s91, s85, 4
    buffer_load_dwordx4 v44, s[92:95], s91 offen lds
    s_add_u32 m0, m0, 1024
    s_nop 0
    buffer_load_dwordx4 v45, s[92:95], s91 offen lds
    s_add_u32 m0, s87, 14336
    s_add_u32 s91, s91, 16384
    buffer_load_dwordx4 v44, s[92:95], s91 offen lds
    s_add_u32 m0, m0, 1024
    s_nop 0
    buffer_load_dwordx4 v45, s[92:95], s91 offen lds
    s_add_u32 m0, s87, 16384
    s_add_u32 s91, s91, 16384
    buffer_load_dwordx4 v44, s[92:95], s91 offen lds
    s_add_u32 m0, m0, 1024
    s_nop 0
    buffer_load_dwordx4 v45, s[92:95], s91 offen lds
    s_add_u32 m0, s87, 18432
    s_add_u32 s91, s91, 16384
    buffer_load_dwordx4 v44, s[92:95], s91 offen lds
    s_add_u32 m0, m0, 1024
    s_nop 0
    buffer_load_dwordx4 v45, s[92:95], s91 offen lds
    s_add_u32 m0, s87, 20480
    s_lshl_b32 s91, s86, 4
    buffer_load_dwordx4 v44, s[92:95], s91 offen lds
    s_add_u32 m0, m0, 1024
    s_nop 0
    buffer_load_dwordx4 v45, s[92:95], s91 offen lds
    s_add_u32 m0, s87, 22528
    s_add_u32 s91, s91, 16384
    buffer_load_dwordx4 v44, s[92:95], s91 offen lds
    s_add_u32 m0, m0, 1024
    s_nop 0
    buffer_load_dwordx4 v45, s[92:95], s91 offen lds
    s_add_u32 m0, s87, 24576
    s_add_u32 s91, s91, 16384
    buffer_load_dwordx4 v44, s[92:95], s91 offen lds
    s_add_u32 m0, m0, 1024
    s_nop 0
    buffer_load_dwordx4 v45, s[92:95], s91 offen lds
    s_add_u32 m0, s87, 26624
    s_add_u32 s91, s91, 16384
    buffer_load_dwordx4 v44, s[92:95], s91 offen lds
    s_add_u32 m0, m0, 1024
    s_nop 0
    buffer_load_dwordx4 v45, s[92:95], s91 offen lds
    s_branch Lp2_main
Lg_comp:
    s_and_b32 s11, s3, 1
    s_lshr_b32 s12, s3, 1
    s_lshl_b32 s13, s12, 7
    s_add_u32 s13, s13, s8
    v_lshrrev_b32 v5, 5, v1
    v_lshl_add_u32 v7, v5, 3, s13
    s_waitcnt lgkmcnt(0)
    s_mov_b32 s60, s34
    s_mov_b32 s61, s35
    s_mov_b32 s62, 3584
    s_mov_b32 s63, 0x20000
    s_mov_b32 s56, s46
    s_mov_b32 s57, s47
    s_mov_b32 s58, 7340032
    s_mov_b32 s59, 0x20000
    buffer_load_dwordx2 v[80:81], v7, s[60:63], 0 offen offset:0
    buffer_load_dwordx2 v[82:83], v7, s[60:63], 0 offen offset:16
    buffer_load_dwordx2 v[84:85], v7, s[60:63], 0 offen offset:32
    buffer_load_dwordx2 v[86:87], v7, s[60:63], 0 offen offset:48
    buffer_load_dwordx2 v[88:89], v7, s[60:63], 0 offen offset:64
    buffer_load_dwordx2 v[90:91], v7, s[60:63], 0 offen offset:80
    buffer_load_dwordx2 v[92:93], v7, s[60:63], 0 offen offset:96
    buffer_load_dwordx2 v[94:95], v7, s[60:63], 0 offen offset:112
    v_and_b32 v6, 31, v1
    v_bfe_u32 v7, v1, 1, 3
    v_xor_b32 v7, v7, v5
    v_lshlrev_b32 v7, 4, v7
    v_lshl_add_u32 v7, v6, 7, v7
    s_lshl_b32 s13, s11, 14
    v_add_u32 v8, s13, v7
    v_xor_b32 v9, 32, v8
    v_xor_b32 v10, 64, v8
    v_xor_b32 v11, 96, v8
    v_add_u32 v12, 98304, v8
    v_add_u32 v13, 98304, v9
    v_add_u32 v14, 98304, v10
    v_add_u32 v15, 98304, v11
    v_bfe_u32 v6, v1, 2, 2
    v_lshl_add_u32 v7, v5, 3, v6
    v_lshlrev_b32 v7, 8, v7
    v_bfe_u32 v19, v1, 4, 1
    v_bfe_u32 v20, v1, 1, 1
    v_lshl_add_u32 v19, v19, 1, v20
    s_lshl_b32 s13, s12, 3
    v_add_u32 v19, s13, v19
    v_lshlrev_b32 v6, 2, v6
    v_xor_b32 v19, v19, v6
    v_lshl_add_u32 v7, v19, 4, v7
    v_and_b32 v20, 1, v1
    v_lshl_add_u32 v7, v20, 3, v7
    v_add_u32 v16, 32768, v7
    v_xor_b32 v17, 64, v16
    v_add_u32 v22, 98304, v16
    v_add_u32 v23, 98304, v17
    s_lshl_b32 s68, s4, 1
    s_add_u32 s68, s68, s11
    s_lshl_b32 s68, s68, 5
    s_lshl_b32 s13, s5, 1
    s_add_u32 s68, s68, s13
    s_add_u32 s68, s68, s12
    s_lshl_b32 s68, s68, 7
    s_add_u32 s68, s68, 11288576
    s_mul_i32 s90, s3, 40960
    s_lshl_b32 s13, s4, 3
    s_lshl_b32 s14, s11, 2
    s_add_u32 s13, s13, s14
    s_mul_i32 s13, s13, 112
    s_lshl_b32 s14, s5, 3
    s_add_u32 s13, s13, s14
    s_lshl_b32 s14, s12, 2
    s_add_u32 s13, s13, s14
    s_lshl_b32 s13, s13, 10
    v_lshl_add_u32 v18, v1, 4, s13
    v_and_b32 v28, 31, v1
    v_lshl_add_u32 v28, v28, 7, s13
    v_mul_u32_u24 v29, 114688, v5
    v_add_u32 v28, v28, v29
    s_mov_b32 s65, 114688
    s_mov_b32 s66, 229376
    s_mov_b32 s67, 344064
    s_waitcnt vmcnt(0)
    v_lshlrev_b32 v96, 16, v80
    v_and_b32 v97, 0xffff0000, v80
    v_lshlrev_b32 v98, 16, v81
    v_and_b32 v99, 0xffff0000, v81
    v_lshlrev_b32 v100, 16, v82
    v_and_b32 v101, 0xffff0000, v82
    v_lshlrev_b32 v102, 16, v83
    v_and_b32 v103, 0xffff0000, v83
    v_lshlrev_b32 v104, 16, v84
    v_and_b32 v105, 0xffff0000, v84
    v_lshlrev_b32 v106, 16, v85
    v_and_b32 v107, 0xffff0000, v85
    v_lshlrev_b32 v108, 16, v86
    v_and_b32 v109, 0xffff0000, v86
    v_lshlrev_b32 v110, 16, v87
    v_and_b32 v111, 0xffff0000, v87
    v_lshlrev_b32 v112, 16, v88
    v_and_b32 v113, 0xffff0000, v88
    v_lshlrev_b32 v114, 16, v89
    v_and_b32 v115, 0xffff0000, v89
    v_lshlrev_b32 v116, 16, v90
    v_and_b32 v117, 0xffff0000, v90
    v_lshlrev_b32 v118, 16, v91
    v_and_b32 v119, 0xffff0000, v91
    v_lshlrev_b32 v120, 16, v92
    v_and_b32 v121, 0xffff0000, v92
    v_lshlrev_b32 v122, 16, v93
    v_and_b32 v123, 0xffff0000, v93
    v_lshlrev_b32 v124, 16, v94
    v_and_b32 v125, 0xffff0000, v94
    v_lshlrev_b32 v126, 16, v95
    v_and_b32 v127, 0xffff0000, v95
    s_barrier
    ds_read_b64_tr_b16 v[48:49], v16 offset:0
    ds_read_b64_tr_b16 v[50:51], v16 offset:1024
    ds_read_b128 v[32:35], v8 offset:0
    ds_read_b128 v[36:39], v8 offset:4096
    ds_read_b128 v[40:43], v8 offset:8192
    ds_read_b128 v[44:47], v8 offset:12288
    ds_read_b64_tr_b16 v[52:53], v17 offset:0
    ds_read_b64_tr_b16 v[54:55], v17 offset:1024
    s_waitcnt lgkmcnt(0)
    v_mfma_f32_32x32x16_bf16 v[128:143], v[48:51], v[32:35], v[96:111]
    ds_read_b64_tr_b16 v[72:73], v16 offset:4096
    ds_read_b64_tr_b16 v[74:75], v16 offset:5120
    v_mfma_f32_32x32x16_bf16 v[144:159], v[48:51], v[36:39], v[96:111]
    ds_read_b128 v[56:59], v9 offset:0
    ds_read_b128 v[60:63], v9 offset:4096
    v_mfma_f32_32x32x16_bf16 v[160:175], v[48:51], v[40:43], v[96:111]
    ds_read_b128 v[64:67], v9 offset:8192
    ds_read_b128 v[68:71], v9 offset:12288
    v_mfma_f32_32x32x16_bf16 v[176:191], v[48:51], v[44:47], v[96:111]
    ds_read_b64_tr_b16 v[76:77], v17 offset:4096
    ds_read_b64_tr_b16 v[78:79], v17 offset:5120
    v_mfma_f32_32x32x16_bf16 v[192:207], v[52:55], v[32:35], v[112:127]
    v_mfma_f32_32x32x16_bf16 v[208:223], v[52:55], v[36:39], v[112:127]
    v_mfma_f32_32x32x16_bf16 v[224:239], v[52:55], v[40:43], v[112:127]
    v_mfma_f32_32x32x16_bf16 v[240:255], v[52:55], v[44:47], v[112:127]
    s_waitcnt lgkmcnt(0)
    v_mfma_f32_32x32x16_bf16 v[128:143], v[72:75], v[56:59], v[128:143]
    ds_read_b64_tr_b16 v[48:49], v16 offset:8192
    ds_read_b64_tr_b16 v[50:51], v16 offset:9216
    v_mfma_f32_32x32x16_bf16 v[144:159], v[72:75], v[60:63], v[144:159]
    ds_read_b128 v[32:35], v10 offset:0
    ds_read_b128 v[36:39], v10 offset:4096
    v_mfma_f32_32x32x16_bf16 v[160:175], v[72:75], v[64:67], v[160:175]
    ds_read_b128 v[40:43], v10 offset:8192
    ds_read_b128 v[44:47], v10 offset:12288
    v_mfma_f32_32x32x16_bf16 v[176:191], v[72:75], v[68:71], v[176:191]
    ds_read_b64_tr_b16 v[52:53], v17 offset:8192
    ds_read_b64_tr_b16 v[54:55], v17 offset:9216
    v_mfma_f32_32x32x16_bf16 v[192:207], v[76:79], v[56:59], v[192:207]
    v_mfma_f32_32x32x16_bf16 v[208:223], v[76:79], v[60:63], v[208:223]
    v_mfma_f32_32x32x16_bf16 v[224:239], v[76:79], v[64:67], v[224:239]
    v_mfma_f32_32x32x16_bf16 v[240:255], v[76:79], v[68:71], v[240:255]
    s_waitcnt lgkmcnt(0)
    v_mfma_f32_32x32x16_bf16 v[128:143], v[48:51], v[32:35], v[128:143]
    ds_read_b64_tr_b16 v[72:73], v16 offset:12288
    ds_read_b64_tr_b16 v[74:75], v16 offset:13312
    v_mfma_f32_32x32x16_bf16 v[144:159], v[48:51], v[36:39], v[144:159]
    ds_read_b128 v[56:59], v11 offset:0
    ds_read_b128 v[60:63], v11 offset:4096
    v_mfma_f32_32x32x16_bf16 v[160:175], v[48:51], v[40:43], v[160:175]
    ds_read_b128 v[64:67], v11 offset:8192
    ds_read_b128 v[68:71], v11 offset:12288
    v_mfma_f32_32x32x16_bf16 v[176:191], v[48:51], v[44:47], v[176:191]
    ds_read_b64_tr_b16 v[76:77], v17 offset:12288
    ds_read_b64_tr_b16 v[78:79], v17 offset:13312
    v_mfma_f32_32x32x16_bf16 v[192:207], v[52:55], v[32:35], v[192:207]
    v_mfma_f32_32x32x16_bf16 v[208:223], v[52:55], v[36:39], v[208:223]
    v_mfma_f32_32x32x16_bf16 v[224:239], v[52:55], v[40:43], v[224:239]
    v_mfma_f32_32x32x16_bf16 v[240:255], v[52:55], v[44:47], v[240:255]
    s_waitcnt lgkmcnt(0)
    s_barrier
    v_mfma_f32_32x32x16_bf16 v[128:143], v[72:75], v[56:59], v[128:143]
    ds_read_b64_tr_b16 v[48:49], v16 offset:49152
    ds_read_b64_tr_b16 v[50:51], v16 offset:50176
    v_mfma_f32_32x32x16_bf16 v[144:159], v[72:75], v[60:63], v[144:159]
    ds_read_b128 v[32:35], v8 offset:49152
    ds_read_b128 v[36:39], v8 offset:53248
    v_mfma_f32_32x32x16_bf16 v[160:175], v[72:75], v[64:67], v[160:175]
    ds_read_b128 v[40:43], v8 offset:57344
    ds_read_b128 v[44:47], v8 offset:61440
    v_mfma_f32_32x32x16_bf16 v[176:191], v[72:75], v[68:71], v[176:191]
    ds_read_b64_tr_b16 v[52:53], v17 offset:49152
    ds_read_b64_tr_b16 v[54:55], v17 offset:50176
    v_mfma_f32_32x32x16_bf16 v[192:207], v[76:79], v[56:59], v[192:207]
    v_mfma_f32_32x32x16_bf16 v[208:223], v[76:79], v[60:63], v[208:223]
    v_mfma_f32_32x32x16_bf16 v[224:239], v[76:79], v[64:67], v[224:239]
    v_mfma_f32_32x32x16_bf16 v[240:255], v[76:79], v[68:71], v[240:255]
    s_waitcnt lgkmcnt(0)
    v_mfma_f32_32x32x16_bf16 v[128:143], v[48:51], v[32:35], v[128:143]
    ds_read_b64_tr_b16 v[72:73], v16 offset:53248
    ds_read_b64_tr_b16 v[74:75], v16 offset:54272
    v_mfma_f32_32x32x16_bf16 v[144:159], v[48:51], v[36:39], v[144:159]
    ds_read_b128 v[56:59], v9 offset:49152
    ds_read_b128 v[60:63], v9 offset:53248
    v_mfma_f32_32x32x16_bf16 v[160:175], v[48:51], v[40:43], v[160:175]
    ds_read_b128 v[64:67], v9 offset:57344
    ds_read_b128 v[68:71], v9 offset:61440
    v_mfma_f32_32x32x16_bf16 v[176:191], v[48:51], v[44:47], v[176:191]
    ds_read_b64_tr_b16 v[76:77], v17 offset:53248
    ds_read_b64_tr_b16 v[78:79], v17 offset:54272
    v_mfma_f32_32x32x16_bf16 v[192:207], v[52:55], v[32:35], v[192:207]
    v_mfma_f32_32x32x16_bf16 v[208:223], v[52:55], v[36:39], v[208:223]
    v_mfma_f32_32x32x16_bf16 v[224:239], v[52:55], v[40:43], v[224:239]
    v_mfma_f32_32x32x16_bf16 v[240:255], v[52:55], v[44:47], v[240:255]
    s_waitcnt lgkmcnt(0)
    v_mfma_f32_32x32x16_bf16 v[128:143], v[72:75], v[56:59], v[128:143]
    ds_read_b64_tr_b16 v[48:49], v16 offset:57344
    ds_read_b64_tr_b16 v[50:51], v16 offset:58368
    v_mfma_f32_32x32x16_bf16 v[144:159], v[72:75], v[60:63], v[144:159]
    ds_read_b128 v[32:35], v10 offset:49152
    ds_read_b128 v[36:39], v10 offset:53248
    v_mfma_f32_32x32x16_bf16 v[160:175], v[72:75], v[64:67], v[160:175]
    ds_read_b128 v[40:43], v10 offset:57344
    ds_read_b128 v[44:47], v10 offset:61440
    v_mfma_f32_32x32x16_bf16 v[176:191], v[72:75], v[68:71], v[176:191]
    ds_read_b64_tr_b16 v[52:53], v17 offset:57344
    ds_read_b64_tr_b16 v[54:55], v17 offset:58368
    v_mfma_f32_32x32x16_bf16 v[192:207], v[76:79], v[56:59], v[192:207]
    v_mfma_f32_32x32x16_bf16 v[208:223], v[76:79], v[60:63], v[208:223]
    v_mfma_f32_32x32x16_bf16 v[224:239], v[76:79], v[64:67], v[224:239]
    v_mfma_f32_32x32x16_bf16 v[240:255], v[76:79], v[68:71], v[240:255]
    s_waitcnt lgkmcnt(0)
    v_mfma_f32_32x32x16_bf16 v[128:143], v[48:51], v[32:35], v[128:143]
    ds_read_b64_tr_b16 v[72:73], v16 offset:61440
    ds_read_b64_tr_b16 v[74:75], v16 offset:62464
    v_mfma_f32_32x32x16_bf16 v[144:159], v[48:51], v[36:39], v[144:159]
    ds_read_b128 v[56:59], v11 offset:49152
    ds_read_b128 v[60:63], v11 offset:53248
    v_mfma_f32_32x32x16_bf16 v[160:175], v[48:51], v[40:43], v[160:175]
    ds_read_b128 v[64:67], v11 offset:57344
    ds_read_b128 v[68:71], v11 offset:61440
    v_mfma_f32_32x32x16_bf16 v[176:191], v[48:51], v[44:47], v[176:191]
    ds_read_b64_tr_b16 v[76:77], v17 offset:61440
    ds_read_b64_tr_b16 v[78:79], v17 offset:62464
    v_mfma_f32_32x32x16_bf16 v[192:207], v[52:55], v[32:35], v[192:207]
    v_mfma_f32_32x32x16_bf16 v[208:223], v[52:55], v[36:39], v[208:223]
    v_mfma_f32_32x32x16_bf16 v[224:239], v[52:55], v[40:43], v[224:239]
    v_mfma_f32_32x32x16_bf16 v[240:255], v[52:55], v[44:47], v[240:255]
    s_waitcnt lgkmcnt(0)
    s_barrier
    v_mfma_f32_32x32x16_bf16 v[128:143], v[72:75], v[56:59], v[128:143]
    ds_read_b64_tr_b16 v[48:49], v22 offset:0
    ds_read_b64_tr_b16 v[50:51], v22 offset:1024
    v_mfma_f32_32x32x16_bf16 v[144:159], v[72:75], v[60:63], v[144:159]
    ds_read_b128 v[32:35], v12 offset:0
    ds_read_b128 v[36:39], v12 offset:4096
    v_mfma_f32_32x32x16_bf16 v[160:175], v[72:75], v[64:67], v[160:175]
    ds_read_b128 v[40:43], v12 offset:8192
    ds_read_b128 v[44:47], v12 offset:12288
    v_mfma_f32_32x32x16_bf16 v[176:191], v[72:75], v[68:71], v[176:191]
    ds_read_b64_tr_b16 v[52:53], v23 offset:0
    ds_read_b64_tr_b16 v[54:55], v23 offset:1024
    v_mfma_f32_32x32x16_bf16 v[192:207], v[76:79], v[56:59], v[192:207]
    v_mfma_f32_32x32x16_bf16 v[208:223], v[76:79], v[60:63], v[208:223]
    v_mfma_f32_32x32x16_bf16 v[224:239], v[76:79], v[64:67], v[224:239]
    v_mfma_f32_32x32x16_bf16 v[240:255], v[76:79], v[68:71], v[240:255]
    s_waitcnt lgkmcnt(0)
    v_mfma_f32_32x32x16_bf16 v[128:143], v[48:51], v[32:35], v[128:143]
    ds_read_b64_tr_b16 v[72:73], v22 offset:4096
    ds_read_b64_tr_b16 v[74:75], v22 offset:5120
    v_mfma_f32_32x32x16_bf16 v[144:159], v[48:51], v[36:39], v[144:159]
    ds_read_b128 v[56:59], v13 offset:0
    ds_read_b128 v[60:63], v13 offset:4096
    v_mfma_f32_32x32x16_bf16 v[160:175], v[48:51], v[40:43], v[160:175]
    ds_read_b128 v[64:67], v13 offset:8192
    ds_read_b128 v[68:71], v13 offset:12288
    v_mfma_f32_32x32x16_bf16 v[176:191], v[48:51], v[44:47], v[176:191]
    ds_read_b64_tr_b16 v[76:77], v23 offset:4096
    ds_read_b64_tr_b16 v[78:79], v23 offset:5120
    v_mfma_f32_32x32x16_bf16 v[192:207], v[52:55], v[32:35], v[192:207]
    v_mfma_f32_32x32x16_bf16 v[208:223], v[52:55], v[36:39], v[208:223]
    v_mfma_f32_32x32x16_bf16 v[224:239], v[52:55], v[40:43], v[224:239]
    v_mfma_f32_32x32x16_bf16 v[240:255], v[52:55], v[44:47], v[240:255]
    s_waitcnt lgkmcnt(0)
    v_mfma_f32_32x32x16_bf16 v[128:143], v[72:75], v[56:59], v[128:143]
    ds_read_b64_tr_b16 v[48:49], v22 offset:8192
    ds_read_b64_tr_b16 v[50:51], v22 offset:9216
    v_mfma_f32_32x32x16_bf16 v[144:159], v[72:75], v[60:63], v[144:159]
    ds_read_b128 v[32:35], v14 offset:0
    ds_read_b128 v[36:39], v14 offset:4096
    v_mfma_f32_32x32x16_bf16 v[160:175], v[72:75], v[64:67], v[160:175]
    ds_read_b128 v[40:43], v14 offset:8192
    ds_read_b128 v[44:47], v14 offset:12288
    v_mfma_f32_32x32x16_bf16 v[176:191], v[72:75], v[68:71], v[176:191]
    ds_read_b64_tr_b16 v[52:53], v23 offset:8192
    ds_read_b64_tr_b16 v[54:55], v23 offset:9216
    v_mfma_f32_32x32x16_bf16 v[192:207], v[76:79], v[56:59], v[192:207]
    v_mfma_f32_32x32x16_bf16 v[208:223], v[76:79], v[60:63], v[208:223]
    v_mfma_f32_32x32x16_bf16 v[224:239], v[76:79], v[64:67], v[224:239]
    v_mfma_f32_32x32x16_bf16 v[240:255], v[76:79], v[68:71], v[240:255]
    s_waitcnt lgkmcnt(0)
    v_mfma_f32_32x32x16_bf16 v[128:143], v[48:51], v[32:35], v[128:143]
    ds_read_b64_tr_b16 v[72:73], v22 offset:12288
    ds_read_b64_tr_b16 v[74:75], v22 offset:13312
    v_mfma_f32_32x32x16_bf16 v[144:159], v[48:51], v[36:39], v[144:159]
    ds_read_b128 v[56:59], v15 offset:0
    ds_read_b128 v[60:63], v15 offset:4096
    v_mfma_f32_32x32x16_bf16 v[160:175], v[48:51], v[40:43], v[160:175]
    ds_read_b128 v[64:67], v15 offset:8192
    ds_read_b128 v[68:71], v15 offset:12288
    v_mfma_f32_32x32x16_bf16 v[176:191], v[48:51], v[44:47], v[176:191]
    ds_read_b64_tr_b16 v[76:77], v23 offset:12288
    ds_read_b64_tr_b16 v[78:79], v23 offset:13312
    v_mfma_f32_32x32x16_bf16 v[192:207], v[52:55], v[32:35], v[192:207]
    v_mfma_f32_32x32x16_bf16 v[208:223], v[52:55], v[36:39], v[208:223]
    v_mfma_f32_32x32x16_bf16 v[224:239], v[52:55], v[40:43], v[224:239]
    v_mfma_f32_32x32x16_bf16 v[240:255], v[52:55], v[44:47], v[240:255]
    s_waitcnt lgkmcnt(0)
    s_barrier
    v_mfma_f32_32x32x16_bf16 v[128:143], v[72:75], v[56:59], v[128:143]
    ds_read_b64_tr_b16 v[48:49], v16 offset:0
    ds_read_b64_tr_b16 v[50:51], v16 offset:1024
    v_mfma_f32_32x32x16_bf16 v[144:159], v[72:75], v[60:63], v[144:159]
    ds_read_b128 v[32:35], v8 offset:0
    ds_read_b128 v[36:39], v8 offset:4096
    v_mfma_f32_32x32x16_bf16 v[160:175], v[72:75], v[64:67], v[160:175]
    ds_read_b128 v[40:43], v8 offset:8192
    ds_read_b128 v[44:47], v8 offset:12288
    v_mfma_f32_32x32x16_bf16 v[176:191], v[72:75], v[68:71], v[176:191]
    ds_read_b64_tr_b16 v[52:53], v17 offset:0
    ds_read_b64_tr_b16 v[54:55], v17 offset:1024
    v_mfma_f32_32x32x16_bf16 v[192:207], v[76:79], v[56:59], v[192:207]
    v_mfma_f32_32x32x16_bf16 v[208:223], v[76:79], v[60:63], v[208:223]
    v_mfma_f32_32x32x16_bf16 v[224:239], v[76:79], v[64:67], v[224:239]
    v_mfma_f32_32x32x16_bf16 v[240:255], v[76:79], v[68:71], v[240:255]
    s_waitcnt lgkmcnt(0)
    v_mfma_f32_32x32x16_bf16 v[128:143], v[48:51], v[32:35], v[128:143]
    ds_read_b64_tr_b16 v[72:73], v16 offset:4096
    ds_read_b64_tr_b16 v[74:75], v16 offset:5120
    v_mfma_f32_32x32x16_bf16 v[144:159], v[48:51], v[36:39], v[144:159]
    ds_read_b128 v[56:59], v9 offset:0
    ds_read_b128 v[60:63], v9 offset:4096
    v_mfma_f32_32x32x16_bf16 v[160:175], v[48:51], v[40:43], v[160:175]
    ds_read_b128 v[64:67], v9 offset:8192
    ds_read_b128 v[68:71], v9 offset:12288
    v_mfma_f32_32x32x16_bf16 v[176:191], v[48:51], v[44:47], v[176:191]
    ds_read_b64_tr_b16 v[76:77], v17 offset:4096
    ds_read_b64_tr_b16 v[78:79], v17 offset:5120
    v_mfma_f32_32x32x16_bf16 v[192:207], v[52:55], v[32:35], v[192:207]
    v_mfma_f32_32x32x16_bf16 v[208:223], v[52:55], v[36:39], v[208:223]
    v_mfma_f32_32x32x16_bf16 v[224:239], v[52:55], v[40:43], v[224:239]
    v_mfma_f32_32x32x16_bf16 v[240:255], v[52:55], v[44:47], v[240:255]
    s_waitcnt lgkmcnt(0)
    v_mfma_f32_32x32x16_bf16 v[128:143], v[72:75], v[56:59], v[128:143]
    ds_read_b64_tr_b16 v[48:49], v16 offset:8192
    ds_read_b64_tr_b16 v[50:51], v16 offset:9216
    v_mfma_f32_32x32x16_bf16 v[144:159], v[72:75], v[60:63], v[144:159]
    ds_read_b128 v[32:35], v10 offset:0
    ds_read_b128 v[36:39], v10 offset:4096
    v_mfma_f32_32x32x16_bf16 v[160:175], v[72:75], v[64:67], v[160:175]
    ds_read_b128 v[40:43], v10 offset:8192
    ds_read_b128 v[44:47], v10 offset:12288
    v_mfma_f32_32x32x16_bf16 v[176:191], v[72:75], v[68:71], v[176:191]
    ds_read_b64_tr_b16 v[52:53], v17 offset:8192
    ds_read_b64_tr_b16 v[54:55], v17 offset:9216
    v_mfma_f32_32x32x16_bf16 v[192:207], v[76:79], v[56:59], v[192:207]
    v_mfma_f32_32x32x16_bf16 v[208:223], v[76:79], v[60:63], v[208:223]
    v_mfma_f32_32x32x16_bf16 v[224:239], v[76:79], v[64:67], v[224:239]
    v_mfma_f32_32x32x16_bf16 v[240:255], v[76:79], v[68:71], v[240:255]
    s_waitcnt lgkmcnt(0)
    v_mfma_f32_32x32x16_bf16 v[128:143], v[48:51], v[32:35], v[128:143]
    ds_read_b64_tr_b16 v[72:73], v16 offset:12288
    ds_read_b64_tr_b16 v[74:75], v16 offset:13312
    v_mfma_f32_32x32x16_bf16 v[144:159], v[48:51], v[36:39], v[144:159]
    ds_read_b128 v[56:59], v11 offset:0
    ds_read_b128 v[60:63], v11 offset:4096
    v_mfma_f32_32x32x16_bf16 v[160:175], v[48:51], v[40:43], v[160:175]
    ds_read_b128 v[64:67], v11 offset:8192
    ds_read_b128 v[68:71], v11 offset:12288
    v_mfma_f32_32x32x16_bf16 v[176:191], v[48:51], v[44:47], v[176:191]
    ds_read_b64_tr_b16 v[76:77], v17 offset:12288
    ds_read_b64_tr_b16 v[78:79], v17 offset:13312
    v_mfma_f32_32x32x16_bf16 v[192:207], v[52:55], v[32:35], v[192:207]
    v_mfma_f32_32x32x16_bf16 v[208:223], v[52:55], v[36:39], v[208:223]
    v_mfma_f32_32x32x16_bf16 v[224:239], v[52:55], v[40:43], v[224:239]
    v_mfma_f32_32x32x16_bf16 v[240:255], v[52:55], v[44:47], v[240:255]
    s_waitcnt lgkmcnt(0)
    s_barrier
    v_mfma_f32_32x32x16_bf16 v[128:143], v[72:75], v[56:59], v[128:143]
    ds_read_b64_tr_b16 v[48:49], v16 offset:49152
    ds_read_b64_tr_b16 v[50:51], v16 offset:50176
    v_mfma_f32_32x32x16_bf16 v[144:159], v[72:75], v[60:63], v[144:159]
    ds_read_b128 v[32:35], v8 offset:49152
    ds_read_b128 v[36:39], v8 offset:53248
    v_mfma_f32_32x32x16_bf16 v[160:175], v[72:75], v[64:67], v[160:175]
    ds_read_b128 v[40:43], v8 offset:57344
    ds_read_b128 v[44:47], v8 offset:61440
    v_mfma_f32_32x32x16_bf16 v[176:191], v[72:75], v[68:71], v[176:191]
    ds_read_b64_tr_b16 v[52:53], v17 offset:49152
    ds_read_b64_tr_b16 v[54:55], v17 offset:50176
    v_mfma_f32_32x32x16_bf16 v[192:207], v[76:79], v[56:59], v[192:207]
    v_mfma_f32_32x32x16_bf16 v[208:223], v[76:79], v[60:63], v[208:223]
    v_mfma_f32_32x32x16_bf16 v[224:239], v[76:79], v[64:67], v[224:239]
    v_mfma_f32_32x32x16_bf16 v[240:255], v[76:79], v[68:71], v[240:255]
    s_waitcnt lgkmcnt(0)
    v_mov_b32 v4, 0
    global_load_dword v4, v4, s[44:45]
    v_mfma_f32_32x32x16_bf16 v[128:143], v[48:51], v[32:35], v[128:143]
    ds_read_b64_tr_b16 v[72:73], v16 offset:53248
    ds_read_b64_tr_b16 v[74:75], v16 offset:54272
    v_mfma_f32_32x32x16_bf16 v[144:159], v[48:51], v[36:39], v[144:159]
    ds_read_b128 v[56:59], v9 offset:49152
    ds_read_b128 v[60:63], v9 offset:53248
    v_mfma_f32_32x32x16_bf16 v[160:175], v[48:51], v[40:43], v[160:175]
    ds_read_b128 v[64:67], v9 offset:57344
    ds_read_b128 v[68:71], v9 offset:61440
    v_mfma_f32_32x32x16_bf16 v[176:191], v[48:51], v[44:47], v[176:191]
    ds_read_b64_tr_b16 v[76:77], v17 offset:53248
    ds_read_b64_tr_b16 v[78:79], v17 offset:54272
    v_mfma_f32_32x32x16_bf16 v[192:207], v[52:55], v[32:35], v[192:207]
    v_mfma_f32_32x32x16_bf16 v[208:223], v[52:55], v[36:39], v[208:223]
    v_mfma_f32_32x32x16_bf16 v[224:239], v[52:55], v[40:43], v[224:239]
    v_mfma_f32_32x32x16_bf16 v[240:255], v[52:55], v[44:47], v[240:255]
    s_waitcnt lgkmcnt(0)
    v_mfma_f32_32x32x16_bf16 v[128:143], v[72:75], v[56:59], v[128:143]
    ds_read_b64_tr_b16 v[48:49], v16 offset:57344
    ds_read_b64_tr_b16 v[50:51], v16 offset:58368
    v_mfma_f32_32x32x16_bf16 v[144:159], v[72:75], v[60:63], v[144:159]
    ds_read_b128 v[32:35], v10 offset:49152
    ds_read_b128 v[36:39], v10 offset:53248
    v_mfma_f32_32x32x16_bf16 v[160:175], v[72:75], v[64:67], v[160:175]
    ds_read_b128 v[40:43], v10 offset:57344
    ds_read_b128 v[44:47], v10 offset:61440
    v_mfma_f32_32x32x16_bf16 v[176:191], v[72:75], v[68:71], v[176:191]
    ds_read_b64_tr_b16 v[52:53], v17 offset:57344
    ds_read_b64_tr_b16 v[54:55], v17 offset:58368
    v_mfma_f32_32x32x16_bf16 v[192:207], v[76:79], v[56:59], v[192:207]
    v_mfma_f32_32x32x16_bf16 v[208:223], v[76:79], v[60:63], v[208:223]
    v_mfma_f32_32x32x16_bf16 v[224:239], v[76:79], v[64:67], v[224:239]
    v_mfma_f32_32x32x16_bf16 v[240:255], v[76:79], v[68:71], v[240:255]
    s_waitcnt lgkmcnt(0)
    v_mfma_f32_32x32x16_bf16 v[128:143], v[48:51], v[32:35], v[128:143]
    ds_read_b64_tr_b16 v[72:73], v16 offset:61440
    ds_read_b64_tr_b16 v[74:75], v16 offset:62464
    v_mfma_f32_32x32x16_bf16 v[144:159], v[48:51], v[36:39], v[144:159]
    ds_read_b128 v[56:59], v11 offset:49152
    ds_read_b128 v[60:63], v11 offset:53248
    v_mfma_f32_32x32x16_bf16 v[160:175], v[48:51], v[40:43], v[160:175]
    ds_read_b128 v[64:67], v11 offset:57344
    ds_read_b128 v[68:71], v11 offset:61440
    v_mfma_f32_32x32x16_bf16 v[176:191], v[48:51], v[44:47], v[176:191]
    ds_read_b64_tr_b16 v[76:77], v17 offset:61440
    ds_read_b64_tr_b16 v[78:79], v17 offset:62464
    v_mfma_f32_32x32x16_bf16 v[192:207], v[52:55], v[32:35], v[192:207]
    v_mfma_f32_32x32x16_bf16 v[208:223], v[52:55], v[36:39], v[208:223]
    v_mfma_f32_32x32x16_bf16 v[224:239], v[52:55], v[40:43], v[224:239]
    v_mfma_f32_32x32x16_bf16 v[240:255], v[52:55], v[44:47], v[240:255]
    s_waitcnt lgkmcnt(0)
    s_barrier
    v_mfma_f32_32x32x16_bf16 v[128:143], v[72:75], v[56:59], v[128:143]
    ds_read_b64_tr_b16 v[48:49], v22 offset:0
    ds_read_b64_tr_b16 v[50:51], v22 offset:1024
    v_mfma_f32_32x32x16_bf16 v[144:159], v[72:75], v[60:63], v[144:159]
    ds_read_b128 v[32:35], v12 offset:0
    ds_read_b128 v[36:39], v12 offset:4096
    v_mfma_f32_32x32x16_bf16 v[160:175], v[72:75], v[64:67], v[160:175]
    ds_read_b128 v[40:43], v12 offset:8192
    ds_read_b128 v[44:47], v12 offset:12288
    v_mfma_f32_32x32x16_bf16 v[176:191], v[72:75], v[68:71], v[176:191]
    ds_read_b64_tr_b16 v[52:53], v23 offset:0
    ds_read_b64_tr_b16 v[54:55], v23 offset:1024
    v_mfma_f32_32x32x16_bf16 v[192:207], v[76:79], v[56:59], v[192:207]
    v_mfma_f32_32x32x16_bf16 v[208:223], v[76:79], v[60:63], v[208:223]
    v_mfma_f32_32x32x16_bf16 v[224:239], v[76:79], v[64:67], v[224:239]
    v_mfma_f32_32x32x16_bf16 v[240:255], v[76:79], v[68:71], v[240:255]
    s_waitcnt lgkmcnt(0)
    v_mfma_f32_32x32x16_bf16 v[128:143], v[48:51], v[32:35], v[128:143]
    ds_read_b64_tr_b16 v[72:73], v22 offset:4096
    ds_read_b64_tr_b16 v[74:75], v22 offset:5120
    v_mfma_f32_32x32x16_bf16 v[144:159], v[48:51], v[36:39], v[144:159]
    ds_read_b128 v[56:59], v13 offset:0
    ds_read_b128 v[60:63], v13 offset:4096
    v_mfma_f32_32x32x16_bf16 v[160:175], v[48:51], v[40:43], v[160:175]
    ds_read_b128 v[64:67], v13 offset:8192
    ds_read_b128 v[68:71], v13 offset:12288
    v_mfma_f32_32x32x16_bf16 v[176:191], v[48:51], v[44:47], v[176:191]
    ds_read_b64_tr_b16 v[76:77], v23 offset:4096
    ds_read_b64_tr_b16 v[78:79], v23 offset:5120
    v_mfma_f32_32x32x16_bf16 v[192:207], v[52:55], v[32:35], v[192:207]
    v_mfma_f32_32x32x16_bf16 v[208:223], v[52:55], v[36:39], v[208:223]
    v_mfma_f32_32x32x16_bf16 v[224:239], v[52:55], v[40:43], v[224:239]
    v_mfma_f32_32x32x16_bf16 v[240:255], v[52:55], v[44:47], v[240:255]
    s_waitcnt lgkmcnt(0)
    v_mfma_f32_32x32x16_bf16 v[128:143], v[72:75], v[56:59], v[128:143]
    ds_read_b64_tr_b16 v[48:49], v22 offset:8192
    ds_read_b64_tr_b16 v[50:51], v22 offset:9216
    v_mfma_f32_32x32x16_bf16 v[144:159], v[72:75], v[60:63], v[144:159]
    ds_read_b128 v[32:35], v14 offset:0
    ds_read_b128 v[36:39], v14 offset:4096
    v_mfma_f32_32x32x16_bf16 v[160:175], v[72:75], v[64:67], v[160:175]
    ds_read_b128 v[40:43], v14 offset:8192
    ds_read_b128 v[44:47], v14 offset:12288
    v_mfma_f32_32x32x16_bf16 v[176:191], v[72:75], v[68:71], v[176:191]
    ds_read_b64_tr_b16 v[52:53], v23 offset:8192
    ds_read_b64_tr_b16 v[54:55], v23 offset:9216
    v_mfma_f32_32x32x16_bf16 v[192:207], v[76:79], v[56:59], v[192:207]
    v_mfma_f32_32x32x16_bf16 v[208:223], v[76:79], v[60:63], v[208:223]
    v_mfma_f32_32x32x16_bf16 v[224:239], v[76:79], v[64:67], v[224:239]
    v_mfma_f32_32x32x16_bf16 v[240:255], v[76:79], v[68:71], v[240:255]
    s_waitcnt lgkmcnt(0)
    v_mfma_f32_32x32x16_bf16 v[128:143], v[48:51], v[32:35], v[128:143]
    ds_read_b64_tr_b16 v[72:73], v22 offset:12288
    ds_read_b64_tr_b16 v[74:75], v22 offset:13312
    v_mfma_f32_32x32x16_bf16 v[144:159], v[48:51], v[36:39], v[144:159]
    ds_read_b128 v[56:59], v15 offset:0
    ds_read_b128 v[60:63], v15 offset:4096
    v_mfma_f32_32x32x16_bf16 v[160:175], v[48:51], v[40:43], v[160:175]
    ds_read_b128 v[64:67], v15 offset:8192
    ds_read_b128 v[68:71], v15 offset:12288
    v_mfma_f32_32x32x16_bf16 v[176:191], v[48:51], v[44:47], v[176:191]
    ds_read_b64_tr_b16 v[76:77], v23 offset:12288
    ds_read_b64_tr_b16 v[78:79], v23 offset:13312
    v_mfma_f32_32x32x16_bf16 v[192:207], v[52:55], v[32:35], v[192:207]
    v_mfma_f32_32x32x16_bf16 v[208:223], v[52:55], v[36:39], v[208:223]
    v_mfma_f32_32x32x16_bf16 v[224:239], v[52:55], v[40:43], v[224:239]
    v_mfma_f32_32x32x16_bf16 v[240:255], v[52:55], v[44:47], v[240:255]
    s_waitcnt lgkmcnt(0)
    s_barrier
    v_mfma_f32_32x32x16_bf16 v[128:143], v[72:75], v[56:59], v[128:143]
    ds_read_b64_tr_b16 v[48:49], v16 offset:0
    ds_read_b64_tr_b16 v[50:51], v16 offset:1024
    v_mfma_f32_32x32x16_bf16 v[144:159], v[72:75], v[60:63], v[144:159]
    ds_read_b128 v[32:35], v8 offset:0
    ds_read_b128 v[36:39], v8 offset:4096
    v_mfma_f32_32x32x16_bf16 v[160:175], v[72:75], v[64:67], v[160:175]
    ds_read_b128 v[40:43], v8 offset:8192
    ds_read_b128 v[44:47], v8 offset:12288
    v_mfma_f32_32x32x16_bf16 v[176:191], v[72:75], v[68:71], v[176:191]
    ds_read_b64_tr_b16 v[52:53], v17 offset:0
    ds_read_b64_tr_b16 v[54:55], v17 offset:1024
    v_mfma_f32_32x32x16_bf16 v[192:207], v[76:79], v[56:59], v[192:207]
    v_mfma_f32_32x32x16_bf16 v[208:223], v[76:79], v[60:63], v[208:223]
    v_mfma_f32_32x32x16_bf16 v[224:239], v[76:79], v[64:67], v[224:239]
    v_mfma_f32_32x32x16_bf16 v[240:255], v[76:79], v[68:71], v[240:255]
    s_waitcnt lgkmcnt(0)
    v_mfma_f32_32x32x16_bf16 v[128:143], v[48:51], v[32:35], v[128:143]
    ds_read_b64_tr_b16 v[72:73], v16 offset:4096
    ds_read_b64_tr_b16 v[74:75], v16 offset:5120
    v_mfma_f32_32x32x16_bf16 v[144:159], v[48:51], v[36:39], v[144:159]
    ds_read_b128 v[56:59], v9 offset:0
    ds_read_b128 v[60:63], v9 offset:4096
    v_mfma_f32_32x32x16_bf16 v[160:175], v[48:51], v[40:43], v[160:175]
    ds_read_b128 v[64:67], v9 offset:8192
    ds_read_b128 v[68:71], v9 offset:12288
    v_mfma_f32_32x32x16_bf16 v[176:191], v[48:51], v[44:47], v[176:191]
    ds_read_b64_tr_b16 v[76:77], v17 offset:4096
    ds_read_b64_tr_b16 v[78:79], v17 offset:5120
    v_mfma_f32_32x32x16_bf16 v[192:207], v[52:55], v[32:35], v[192:207]
    v_mfma_f32_32x32x16_bf16 v[208:223], v[52:55], v[36:39], v[208:223]
    v_mfma_f32_32x32x16_bf16 v[224:239], v[52:55], v[40:43], v[224:239]
    v_mfma_f32_32x32x16_bf16 v[240:255], v[52:55], v[44:47], v[240:255]
    s_waitcnt lgkmcnt(0)
    v_mfma_f32_32x32x16_bf16 v[128:143], v[72:75], v[56:59], v[128:143]
    ds_read_b64_tr_b16 v[48:49], v16 offset:8192
    ds_read_b64_tr_b16 v[50:51], v16 offset:9216
    v_mfma_f32_32x32x16_bf16 v[144:159], v[72:75], v[60:63], v[144:159]
    ds_read_b128 v[32:35], v10 offset:0
    ds_read_b128 v[36:39], v10 offset:4096
    v_mfma_f32_32x32x16_bf16 v[160:175], v[72:75], v[64:67], v[160:175]
    ds_read_b128 v[40:43], v10 offset:8192
    ds_read_b128 v[44:47], v10 offset:12288
    v_mfma_f32_32x32x16_bf16 v[176:191], v[72:75], v[68:71], v[176:191]
    ds_read_b64_tr_b16 v[52:53], v17 offset:8192
    ds_read_b64_tr_b16 v[54:55], v17 offset:9216
    v_mfma_f32_32x32x16_bf16 v[192:207], v[76:79], v[56:59], v[192:207]
    v_mfma_f32_32x32x16_bf16 v[208:223], v[76:79], v[60:63], v[208:223]
    v_mfma_f32_32x32x16_bf16 v[224:239], v[76:79], v[64:67], v[224:239]
    v_mfma_f32_32x32x16_bf16 v[240:255], v[76:79], v[68:71], v[240:255]
    s_waitcnt lgkmcnt(0)
    v_mfma_f32_32x32x16_bf16 v[128:143], v[48:51], v[32:35], v[128:143]
    ds_read_b64_tr_b16 v[72:73], v16 offset:12288
    ds_read_b64_tr_b16 v[74:75], v16 offset:13312
    v_mfma_f32_32x32x16_bf16 v[144:159], v[48:51], v[36:39], v[144:159]
    ds_read_b128 v[56:59], v11 offset:0
    ds_read_b128 v[60:63], v11 offset:4096
    v_mfma_f32_32x32x16_bf16 v[160:175], v[48:51], v[40:43], v[160:175]
    ds_read_b128 v[64:67], v11 offset:8192
    ds_read_b128 v[68:71], v11 offset:12288
    v_mfma_f32_32x32x16_bf16 v[176:191], v[48:51], v[44:47], v[176:191]
    ds_read_b64_tr_b16 v[76:77], v17 offset:12288
    ds_read_b64_tr_b16 v[78:79], v17 offset:13312
    v_mfma_f32_32x32x16_bf16 v[192:207], v[52:55], v[32:35], v[192:207]
    v_mfma_f32_32x32x16_bf16 v[208:223], v[52:55], v[36:39], v[208:223]
    v_mfma_f32_32x32x16_bf16 v[224:239], v[52:55], v[40:43], v[224:239]
    v_mfma_f32_32x32x16_bf16 v[240:255], v[52:55], v[44:47], v[240:255]
    s_waitcnt lgkmcnt(0)
    s_barrier
    v_mfma_f32_32x32x16_bf16 v[128:143], v[72:75], v[56:59], v[128:143]
    ds_read_b64_tr_b16 v[32:33], v16 offset:49152
    ds_read_b64_tr_b16 v[34:35], v16 offset:50176
    v_mfma_f32_32x32x16_bf16 v[144:159], v[72:75], v[60:63], v[144:159]
    ds_read_b64_tr_b16 v[36:37], v16 offset:53248
    ds_read_b64_tr_b16 v[38:39], v16 offset:54272
    v_mfma_f32_32x32x16_bf16 v[160:175], v[72:75], v[64:67], v[160:175]
    ds_read_b64_tr_b16 v[40:41], v16 offset:57344
    ds_read_b64_tr_b16 v[42:43], v16 offset:58368
    v_mfma_f32_32x32x16_bf16 v[176:191], v[72:75], v[68:71], v[176:191]
    ds_read_b64_tr_b16 v[44:45], v16 offset:61440
    ds_read_b64_tr_b16 v[46:47], v16 offset:62464
    v_mfma_f32_32x32x16_bf16 v[192:207], v[76:79], v[56:59], v[192:207]
    ds_read_b128 v[48:51], v8 offset:49152
    ds_read_b128 v[52:55], v9 offset:49152
    v_mfma_f32_32x32x16_bf16 v[208:223], v[76:79], v[60:63], v[208:223]
    ds_read_b128 v[80:83], v10 offset:49152
    ds_read_b128 v[84:87], v11 offset:49152
    v_mfma_f32_32x32x16_bf16 v[224:239], v[76:79], v[64:67], v[224:239]
    ds_read_b128 v[88:91], v8 offset:53248
    ds_read_b128 v[92:95], v9 offset:53248
    v_mfma_f32_32x32x16_bf16 v[240:255], v[76:79], v[68:71], v[240:255]
    ds_read_b128 v[96:99], v10 offset:53248
    ds_read_b128 v[100:103], v11 offset:53248
    s_waitcnt lgkmcnt(4)
    v_mfma_f32_32x32x16_bf16 v[128:143], v[32:35], v[48:51], v[128:143]
    ds_read_b128 v[104:107], v8 offset:57344
    ds_read_b128 v[108:111], v9 offset:57344
    v_mfma_f32_32x32x16_bf16 v[128:143], v[36:39], v[52:55], v[128:143]
    ds_read_b128 v[112:115], v10 offset:57344
    ds_read_b128 v[116:119], v11 offset:57344
    v_mfma_f32_32x32x16_bf16 v[128:143], v[40:43], v[80:83], v[128:143]
    ds_read_b128 v[120:123], v8 offset:61440
    ds_read_b128 v[124:127], v9 offset:61440
    v_mfma_f32_32x32x16_bf16 v[128:143], v[44:47], v[84:87], v[128:143]
    ds_read_b128 v[56:59], v10 offset:61440
    ds_read_b128 v[60:63], v11 offset:61440
    s_waitcnt lgkmcnt(8)
    v_mfma_f32_32x32x16_bf16 v[144:159], v[32:35], v[88:91], v[144:159]
    ds_read_b64_tr_b16 v[64:65], v17 offset:49152
    ds_read_b64_tr_b16 v[66:67], v17 offset:50176
    v_mfma_f32_32x32x16_bf16 v[144:159], v[36:39], v[92:95], v[144:159]
    ds_read_b64_tr_b16 v[68:69], v17 offset:53248
    ds_read_b64_tr_b16 v[70:71], v17 offset:54272
    v_mfma_f32_32x32x16_bf16 v[144:159], v[40:43], v[96:99], v[144:159]
    ds_read_b64_tr_b16 v[72:73], v17 offset:57344
    ds_read_b64_tr_b16 v[74:75], v17 offset:58368
    v_max_f32 v128, 0, v128
    v_max_f32 v129, 0, v129
    v_max_f32 v130, 0, v130
    v_max_f32 v131, 0, v131
    v_max_f32 v132, 0, v132
    v_max_f32 v133, 0, v133
    v_max_f32 v134, 0, v134
    v_max_f32 v135, 0, v135
    v_max_f32 v136, 0, v136
    v_mfma_f32_32x32x16_bf16 v[144:159], v[44:47], v[100:103], v[144:159]
    ds_read_b64_tr_b16 v[76:77], v17 offset:61440
    ds_read_b64_tr_b16 v[78:79], v17 offset:62464
    v_max_f32 v137, 0, v137
    v_max_f32 v138, 0, v138
    v_max_f32 v139, 0, v139
    v_max_f32 v140, 0, v140
    v_max_f32 v141, 0, v141
    v_max_f32 v142, 0, v142
    v_max_f32 v143, 0, v143
    v_pk_mul_f32 v[128:129], v[128:129], v[128:129]
    v_pk_mul_f32 v[130:131], v[130:131], v[130:131]
    s_waitcnt lgkmcnt(12)
    v_mfma_f32_32x32x16_bf16 v[160:175], v[32:35], v[104:107], v[160:175]
    v_pk_mul_f32 v[132:133], v[132:133], v[132:133]
    v_pk_mul_f32 v[134:135], v[134:135], v[134:135]
    v_pk_mul_f32 v[136:137], v[136:137], v[136:137]
    v_pk_mul_f32 v[138:139], v[138:139], v[138:139]
    v_pk_mul_f32 v[140:141], v[140:141], v[140:141]
    v_pk_mul_f32 v[142:143], v[142:143], v[142:143]
    v_cvt_pk_bf16_f32 v128, v128, v129
    v_cvt_pk_bf16_f32 v129, v130, v131
    v_cvt_pk_bf16_f32 v130, v132, v133
    v_mfma_f32_32x32x16_bf16 v[160:175], v[36:39], v[108:111], v[160:175]
    v_cvt_pk_bf16_f32 v131, v134, v135
    v_cvt_pk_bf16_f32 v132, v136, v137
    v_cvt_pk_bf16_f32 v133, v138, v139
    v_cvt_pk_bf16_f32 v134, v140, v141
    v_cvt_pk_bf16_f32 v135, v142, v143
    buffer_store_dwordx4 v[128:131], v18, s[56:59], 0 offen offset:0 sc1
    buffer_store_dwordx4 v[132:135], v18, s[56:59], 0 offen offset:1024 sc1
    v_max_f32 v144, 0, v144
    v_max_f32 v145, 0, v145
    v_mfma_f32_32x32x16_bf16 v[160:175], v[40:43], v[112:115], v[160:175]
    v_max_f32 v146, 0, v146
    v_max_f32 v147, 0, v147
    v_max_f32 v148, 0, v148
    v_max_f32 v149, 0, v149
    v_max_f32 v150, 0, v150
    v_max_f32 v151, 0, v151
    v_max_f32 v152, 0, v152
    v_max_f32 v153, 0, v153
    v_max_f32 v154, 0, v154
    v_mfma_f32_32x32x16_bf16 v[160:175], v[44:47], v[116:119], v[160:175]
    v_max_f32 v155, 0, v155
    v_max_f32 v156, 0, v156
    v_max_f32 v157, 0, v157
    v_max_f32 v158, 0, v158
    v_max_f32 v159, 0, v159
    v_pk_mul_f32 v[144:145], v[144:145], v[144:145]
    v_pk_mul_f32 v[146:147], v[146:147], v[146:147]
    v_pk_mul_f32 v[148:149], v[148:149], v[148:149]
    v_pk_mul_f32 v[150:151], v[150:151], v[150:151]
    s_waitcnt lgkmcnt(8)
    v_mfma_f32_32x32x16_bf16 v[176:191], v[32:35], v[120:123], v[176:191]
    v_pk_mul_f32 v[152:153], v[152:153], v[152:153]
    v_pk_mul_f32 v[154:155], v[154:155], v[154:155]
    v_pk_mul_f32 v[156:157], v[156:157], v[156:157]
    v_pk_mul_f32 v[158:159], v[158:159], v[158:159]
    v_cvt_pk_bf16_f32 v144, v144, v145
    v_cvt_pk_bf16_f32 v145, v146, v147
    v_cvt_pk_bf16_f32 v146, v148, v149
    v_cvt_pk_bf16_f32 v147, v150, v151
    v_cvt_pk_bf16_f32 v148, v152, v153
    v_mfma_f32_32x32x16_bf16 v[176:191], v[36:39], v[124:127], v[176:191]
    v_cvt_pk_bf16_f32 v149, v154, v155
    v_cvt_pk_bf16_f32 v150, v156, v157
    v_cvt_pk_bf16_f32 v151, v158, v159
    buffer_store_dwordx4 v[144:147], v18, s[56:59], s65 offen offset:0 sc1
    buffer_store_dwordx4 v[148:151], v18, s[56:59], s65 offen offset:1024 sc1
    v_max_f32 v160, 0, v160
    v_max_f32 v161, 0, v161
    v_max_f32 v162, 0, v162
    v_max_f32 v163, 0, v163
    v_mfma_f32_32x32x16_bf16 v[176:191], v[40:43], v[56:59], v[176:191]
    v_max_f32 v164, 0, v164
    v_max_f32 v165, 0, v165
    v_max_f32 v166, 0, v166
    v_max_f32 v167, 0, v167
    v_max_f32 v168, 0, v168
    v_max_f32 v169, 0, v169
    v_max_f32 v170, 0, v170
    v_max_f32 v171, 0, v171
    v_max_f32 v172, 0, v172
    v_mfma_f32_32x32x16_bf16 v[176:191], v[44:47], v[60:63], v[176:191]
    v_max_f32 v173, 0, v173
    v_max_f32 v174, 0, v174
    v_max_f32 v175, 0, v175
    v_pk_mul_f32 v[160:161], v[160:161], v[160:161]
    v_pk_mul_f32 v[162:163], v[162:163], v[162:163]
    v_pk_mul_f32 v[164:165], v[164:165], v[164:165]
    v_pk_mul_f32 v[166:167], v[166:167], v[166:167]
    v_pk_mul_f32 v[168:169], v[168:169], v[168:169]
    v_pk_mul_f32 v[170:171], v[170:171], v[170:171]
    s_waitcnt lgkmcnt(0)
    v_mfma_f32_32x32x16_bf16 v[192:207], v[64:67], v[48:51], v[192:207]
    v_pk_mul_f32 v[172:173], v[172:173], v[172:173]
    v_pk_mul_f32 v[174:175], v[174:175], v[174:175]
    v_cvt_pk_bf16_f32 v160, v160, v161
    v_cvt_pk_bf16_f32 v161, v162, v163
    v_cvt_pk_bf16_f32 v162, v164, v165
    v_cvt_pk_bf16_f32 v163, v166, v167
    v_cvt_pk_bf16_f32 v164, v168, v169
    v_cvt_pk_bf16_f32 v165, v170, v171
    v_cvt_pk_bf16_f32 v166, v172, v173
    v_mfma_f32_32x32x16_bf16 v[192:207], v[68:71], v[52:55], v[192:207]
    v_cvt_pk_bf16_f32 v167, v174, v175
    buffer_store_dwordx4 v[160:163], v18, s[56:59], s66 offen offset:0 sc1
    buffer_store_dwordx4 v[164:167], v18, s[56:59], s66 offen offset:1024 sc1
    v_max_f32 v176, 0, v176
    v_max_f32 v177, 0, v177
    v_max_f32 v178, 0, v178
    v_max_f32 v179, 0, v179
    v_max_f32 v180, 0, v180
    v_max_f32 v181, 0, v181
    v_mfma_f32_32x32x16_bf16 v[192:207], v[72:75], v[80:83], v[192:207]
    v_max_f32 v182, 0, v182
    v_max_f32 v183, 0, v183
    v_max_f32 v184, 0, v184
    v_max_f32 v185, 0, v185
    v_max_f32 v186, 0, v186
    v_max_f32 v187, 0, v187
    v_max_f32 v188, 0, v188
    v_max_f32 v189, 0, v189
    v_max_f32 v190, 0, v190
    v_mfma_f32_32x32x16_bf16 v[192:207], v[76:79], v[84:87], v[192:207]
    v_max_f32 v191, 0, v191
    v_pk_mul_f32 v[176:177], v[176:177], v[176:177]
    v_pk_mul_f32 v[178:179], v[178:179], v[178:179]
    v_pk_mul_f32 v[180:181], v[180:181], v[180:181]
    v_pk_mul_f32 v[182:183], v[182:183], v[182:183]
    v_pk_mul_f32 v[184:185], v[184:185], v[184:185]
    v_pk_mul_f32 v[186:187], v[186:187], v[186:187]
    v_pk_mul_f32 v[188:189], v[188:189], v[188:189]
    v_pk_mul_f32 v[190:191], v[190:191], v[190:191]
    v_mfma_f32_32x32x16_bf16 v[208:223], v[64:67], v[88:91], v[208:223]
    v_cvt_pk_bf16_f32 v176, v176, v177
    v_cvt_pk_bf16_f32 v177, v178, v179
    v_cvt_pk_bf16_f32 v178, v180, v181
    v_cvt_pk_bf16_f32 v179, v182, v183
    v_cvt_pk_bf16_f32 v180, v184, v185
    v_cvt_pk_bf16_f32 v181, v186, v187
    v_cvt_pk_bf16_f32 v182, v188, v189
    v_cvt_pk_bf16_f32 v183, v190, v191
    buffer_store_dwordx4 v[176:179], v18, s[56:59], s67 offen offset:0 sc1
    v_mfma_f32_32x32x16_bf16 v[208:223], v[68:71], v[92:95], v[208:223]
    buffer_store_dwordx4 v[180:183], v18, s[56:59], s67 offen offset:1024 sc1
    v_max_f32 v192, 0, v192
    v_max_f32 v193, 0, v193
    v_max_f32 v194, 0, v194
    v_max_f32 v195, 0, v195
    v_max_f32 v196, 0, v196
    v_max_f32 v197, 0, v197
    v_max_f32 v198, 0, v198
    v_max_f32 v199, 0, v199
    v_mfma_f32_32x32x16_bf16 v[208:223], v[72:75], v[96:99], v[208:223]
    v_max_f32 v200, 0, v200
    v_max_f32 v201, 0, v201
    v_max_f32 v202, 0, v202
    v_max_f32 v203, 0, v203
    v_max_f32 v204, 0, v204
    v_max_f32 v205, 0, v205
    v_max_f32 v206, 0, v206
    v_max_f32 v207, 0, v207
    v_pk_mul_f32 v[192:193], v[192:193], v[192:193]
    v_mfma_f32_32x32x16_bf16 v[208:223], v[76:79], v[100:103], v[208:223]
    v_pk_mul_f32 v[194:195], v[194:195], v[194:195]
    v_pk_mul_f32 v[196:197], v[196:197], v[196:197]
    v_pk_mul_f32 v[198:199], v[198:199], v[198:199]
    v_pk_mul_f32 v[200:201], v[200:201], v[200:201]
    v_pk_mul_f32 v[202:203], v[202:203], v[202:203]
    v_pk_mul_f32 v[204:205], v[204:205], v[204:205]
    v_pk_mul_f32 v[206:207], v[206:207], v[206:207]
    v_cvt_pk_bf16_f32 v192, v192, v193
    v_cvt_pk_bf16_f32 v193, v194, v195
    v_mfma_f32_32x32x16_bf16 v[224:239], v[64:67], v[104:107], v[224:239]
    v_cvt_pk_bf16_f32 v194, v196, v197
    v_cvt_pk_bf16_f32 v195, v198, v199
    v_cvt_pk_bf16_f32 v196, v200, v201
    v_cvt_pk_bf16_f32 v197, v202, v203
    v_cvt_pk_bf16_f32 v198, v204, v205
    v_cvt_pk_bf16_f32 v199, v206, v207
    buffer_store_dwordx4 v[192:195], v18, s[56:59], 0 offen offset:2048 sc1
    buffer_store_dwordx4 v[196:199], v18, s[56:59], 0 offen offset:3072 sc1
    v_max_f32 v208, 0, v208
    v_mfma_f32_32x32x16_bf16 v[224:239], v[68:71], v[108:111], v[224:239]
    v_max_f32 v209, 0, v209
    v_max_f32 v210, 0, v210
    v_max_f32 v211, 0, v211
    v_max_f32 v212, 0, v212
    v_max_f32 v213, 0, v213
    v_max_f32 v214, 0, v214
    v_max_f32 v215, 0, v215
    v_max_f32 v216, 0, v216
    v_max_f32 v217, 0, v217
    v_mfma_f32_32x32x16_bf16 v[224:239], v[72:75], v[112:115], v[224:239]
    v_max_f32 v218, 0, v218
    v_max_f32 v219, 0, v219
    v_max_f32 v220, 0, v220
    v_max_f32 v221, 0, v221
    v_max_f32 v222, 0, v222
    v_max_f32 v223, 0, v223
    v_pk_mul_f32 v[208:209], v[208:209], v[208:209]
    v_pk_mul_f32 v[210:211], v[210:211], v[210:211]
    v_pk_mul_f32 v[212:213], v[212:213], v[212:213]
    v_mfma_f32_32x32x16_bf16 v[224:239], v[76:79], v[116:119], v[224:239]
    v_pk_mul_f32 v[214:215], v[214:215], v[214:215]
    v_pk_mul_f32 v[216:217], v[216:217], v[216:217]
    v_pk_mul_f32 v[218:219], v[218:219], v[218:219]
    v_pk_mul_f32 v[220:221], v[220:221], v[220:221]
    v_pk_mul_f32 v[222:223], v[222:223], v[222:223]
    v_cvt_pk_bf16_f32 v208, v208, v209
    v_cvt_pk_bf16_f32 v209, v210, v211
    v_cvt_pk_bf16_f32 v210, v212, v213
    v_cvt_pk_bf16_f32 v211, v214, v215
    v_mfma_f32_32x32x16_bf16 v[240:255], v[64:67], v[120:123], v[240:255]
    v_cvt_pk_bf16_f32 v212, v216, v217
    v_cvt_pk_bf16_f32 v213, v218, v219
    v_cvt_pk_bf16_f32 v214, v220, v221
    v_cvt_pk_bf16_f32 v215, v222, v223
    buffer_store_dwordx4 v[208:211], v18, s[56:59], s65 offen offset:2048 sc1
    buffer_store_dwordx4 v[212:215], v18, s[56:59], s65 offen offset:3072 sc1
    v_max_f32 v224, 0, v224
    v_max_f32 v225, 0, v225
    v_max_f32 v226, 0, v226
    v_mfma_f32_32x32x16_bf16 v[240:255], v[68:71], v[124:127], v[240:255]
    v_max_f32 v227, 0, v227
    v_max_f32 v228, 0, v228
    v_max_f32 v229, 0, v229
    v_max_f32 v230, 0, v230
    v_max_f32 v231, 0, v231
    v_max_f32 v232, 0, v232
    v_max_f32 v233, 0, v233
    v_max_f32 v234, 0, v234
    v_max_f32 v235, 0, v235
    v_mfma_f32_32x32x16_bf16 v[240:255], v[72:75], v[56:59], v[240:255]
    v_max_f32 v236, 0, v236
    v_max_f32 v237, 0, v237
    v_max_f32 v238, 0, v238
    v_max_f32 v239, 0, v239
    v_pk_mul_f32 v[224:225], v[224:225], v[224:225]
    v_pk_mul_f32 v[226:227], v[226:227], v[226:227]
    v_pk_mul_f32 v[228:229], v[228:229], v[228:229]
    v_pk_mul_f32 v[230:231], v[230:231], v[230:231]
    v_pk_mul_f32 v[232:233], v[232:233], v[232:233]
    v_mfma_f32_32x32x16_bf16 v[240:255], v[76:79], v[60:63], v[240:255]
    v_pk_mul_f32 v[234:235], v[234:235], v[234:235]
    v_pk_mul_f32 v[236:237], v[236:237], v[236:237]
    v_pk_mul_f32 v[238:239], v[238:239], v[238:239]
    v_cvt_pk_bf16_f32 v224, v224, v225
    v_cvt_pk_bf16_f32 v225, v226, v227
    v_cvt_pk_bf16_f32 v226, v228, v229
    v_cvt_pk_bf16_f32 v227, v230, v231
    v_cvt_pk_bf16_f32 v228, v232, v233
    v_cvt_pk_bf16_f32 v229, v234, v235
    v_cvt_pk_bf16_f32 v230, v236, v237
    v_cvt_pk_bf16_f32 v231, v238, v239
    buffer_store_dwordx4 v[224:227], v18, s[56:59], s66 offen offset:2048 sc1
    buffer_store_dwordx4 v[228:231], v18, s[56:59], s66 offen offset:3072 sc1
    v_max_f32 v240, 0, v240
    v_max_f32 v241, 0, v241
    v_max_f32 v242, 0, v242
    v_max_f32 v243, 0, v243
    v_max_f32 v244, 0, v244
    v_max_f32 v245, 0, v245
    v_max_f32 v246, 0, v246
    v_max_f32 v247, 0, v247
    v_max_f32 v248, 0, v248
    v_max_f32 v249, 0, v249
    v_max_f32 v250, 0, v250
    v_max_f32 v251, 0, v251
    v_max_f32 v252, 0, v252
    v_max_f32 v253, 0, v253
    v_max_f32 v254, 0, v254
    v_max_f32 v255, 0, v255
    v_pk_mul_f32 v[240:241], v[240:241], v[240:241]
    v_pk_mul_f32 v[242:243], v[242:243], v[242:243]
    v_pk_mul_f32 v[244:245], v[244:245], v[244:245]
    v_pk_mul_f32 v[246:247], v[246:247], v[246:247]
    v_pk_mul_f32 v[248:249], v[248:249], v[248:249]
    v_pk_mul_f32 v[250:251], v[250:251], v[250:251]
    v_pk_mul_f32 v[252:253], v[252:253], v[252:253]
    v_pk_mul_f32 v[254:255], v[254:255], v[254:255]
    v_cvt_pk_bf16_f32 v240, v240, v241
    v_cvt_pk_bf16_f32 v241, v242, v243
    v_cvt_pk_bf16_f32 v242, v244, v245
    v_cvt_pk_bf16_f32 v243, v246, v247
    v_cvt_pk_bf16_f32 v244, v248, v249
    v_cvt_pk_bf16_f32 v245, v250, v251
    v_cvt_pk_bf16_f32 v246, v252, v253
    v_cvt_pk_bf16_f32 v247, v254, v255
    buffer_store_dwordx4 v[240:243], v18, s[56:59], s67 offen offset:2048 sc1
    buffer_store_dwordx4 v[244:247], v18, s[56:59], s67 offen offset:3072 sc1
    s_waitcnt vmcnt(16)
    v_readfirstlane_b32 s79, v4
    s_ff1_i32_b32 s79, s79
    s_cmp_ge_i32 s79, 4
    s_cbranch_scc1 Ltag1
    s_mov_b32 s76, 40000
    v_mov_b32 v20, 0
Ltag1p:
    global_load_dword v4, v20, s[44:45] sc1
    s_sub_u32 s76, s76, 1
    s_waitcnt vmcnt(0)
    v_readfirstlane_b32 s79, v4
    s_ff1_i32_b32 s79, s79
    s_cmp_ge_i32 s79, 4
    s_cbranch_scc1 Ltag1
    s_sleep 12
    s_cmp_lg_u32 s76, 0
    s_cbranch_scc1 Ltag1p
Ltag1:
    s_mov_b32 s79, 16
    s_waitcnt vmcnt(0)
    v_mov_b32 v20, s79
    v_mov_b32 v21, s68
    s_mov_b64 exec, 1
    global_store_dword v21, v20, s[46:47] sc1
    s_mov_b64 exec, -1
    s_barrier
    s_branch Lp2_aux
La_conv:
    s_sub_u32 s5, s5, 14
    s_lshl_b32 s6, s4, 4
    s_add_u32 s6, s6, s5
    s_and_b32 s7, s3, 3
    s_lshl_b32 s8, s6, 2
    s_add_u32 s8, s8, s7
    s_lshl_b32 s9, s8, 8
    v_lshl_add_u32 v2, v1, 2, s9
    s_lshr_b32 s10, s8, 1
    s_lshl_b32 s10, s10, 2
    s_lshl_b32 s11, s6, 3
    s_mul_i32 s12, s7, 40960
    v_lshl_add_u32 v3, v1, 3, s12
    s_mov_b32 s70, 0x3fb8aa3b
    s_lshl_b32 s64, s5, 17
    s_lshl_b32 s65, s3, 14
    s_add_u32 s64, s64, s65
    s_add_u32 s64, s64, s11
    v_and_b32 v9, 15, v1
    v_lshl_add_u32 v9, v9, 10, s64
    s_waitcnt lgkmcnt(0)
    s_load_dword s13, s[26:27], s10
    s_load_dwordx2 s[14:15], s[28:29], s11
    global_load_dword v4, v2, s[18:19]
    global_load_dword v5, v2, s[20:21]
    global_load_dword v6, v2, s[22:23]
    global_load_dword v7, v2, s[24:25]
    global_load_dword v11, v9, s[16:17]
    s_mov_b32 s52, s46
    s_mov_b32 s53, s47
    s_mov_b32 s54, 11427840
    s_mov_b32 s55, 0x20000
    s_mov_b32 s48, s16
    s_mov_b32 s49, s17
    s_mov_b32 s50, 2097152
    s_mov_b32 s51, 0x20000
    v_subrev_u32 v8, 256, v0
    v_lshl_add_u32 v9, v8, 13, s11
    v_subrev_u32 v10, 0x400, v9
    s_movk_i32 s64, 4096
    v_and_b32 v20, 31, v1
    v_lshrrev_b32 v21, 5, v1
    v_mul_u32_u24 v22, 528, v20
    v_lshl_add_u32 v22, v21, 4, v22
    v_add_u32 v22, s12, v22
    v_mov_b32 v23, v20
    v_cmp_le_u32 vcc, 11, v20
    s_nop 1
    v_subbrev_co_u32 v23, vcc, 0, v23, vcc
    v_cmp_le_u32 vcc, 12, v20
    s_nop 1
    v_subbrev_co_u32 v23, vcc, 0, v23, vcc
    v_cmp_le_u32 vcc, 15, v20
    s_nop 1
    v_subbrev_co_u32 v23, vcc, 0, v23, vcc
    v_cmp_le_u32 vcc, 19, v20
    s_nop 1
    v_subbrev_co_u32 v23, vcc, 0, v23, vcc
    v_cmp_le_u32 vcc, 23, v20
    s_nop 1
    v_subbrev_co_u32 v23, vcc, 0, v23, vcc
    v_mul_u32_u24 v23, 528, v23
    v_lshl_add_u32 v23, v21, 4, v23
    s_add_u32 s66, s12, 16896
    v_add_u32 v23, s66, v23
    s_waitcnt lgkmcnt(0)
    s_bitcmp1_b32 s8, 0
    s_cselect_b32 s65, 0, 16
    s_lshl_b32 s13, s13, s65
    s_and_b32 s13, s13, 0xffff0000
    v_mov_b32 v12, s13
    v_mul_f32 v14, s70, v12
    v_fma_f32 v15, v12, s70, -v14
    v_exp_f32 v13, v14
    v_fmac_f32 v15, 0x32a57060, v12
    v_mul_f32 v15, 0x3f317218, v15
    v_fmac_f32 v13, v13, v15
    v_cvt_pk_bf16_f32 v13, v13, v13
    v_and_b32 v13, 0xffff0000, v13
    s_waitcnt vmcnt(3)
    v_lshlrev_b32 v16, 16, v4
    v_and_b32 v17, 0xffff0000, v4
    v_mul_f32 v14, s70, v16
    v_fma_f32 v15, v16, s70, -v14
    v_exp_f32 v18, v14
    v_fmac_f32 v15, 0x32a57060, v16
    v_mul_f32 v15, 0x3f317218, v15
    v_fmac_f32 v18, v18, v15
    v_mul_f32 v24, s70, v17
    v_fma_f32 v25, v17, s70, -v24
    v_exp_f32 v19, v24
    v_fmac_f32 v25, 0x32a57060, v17
    v_mul_f32 v25, 0x3f317218, v25
    v_fmac_f32 v19, v19, v25
    v_cvt_pk_bf16_f32 v18, v18, v19
    v_lshlrev_b32 v16, 16, v18
    v_and_b32 v17, 0xffff0000, v18
    v_lshlrev_b32 v18, 16, v5
    v_and_b32 v19, 0xffff0000, v5
    v_mul_f32 v16, v16, v13
    v_mul_f32 v17, v17, v13
    v_mul_f32 v18, v18, v13
    v_mul_f32 v19, v19, v13
    v_mul_f32 v16, 0xbfb8aa3b, v16
    v_mul_f32 v17, 0xbfb8aa3b, v17
    v_mul_f32 v18, 0.15915494, v18
    v_mul_f32 v19, 0.15915494, v19
    s_cmp_lt_u32 s3, 4
    s_cbranch_scc0 Lc_rwave
    v_mul_f32 v32, 0x41000000, v16
    v_mul_f32 v26, 0x41000000, v18
    v_exp_f32 v32, v32
    v_fract_f32 v26, v26
    v_cos_f32 v24, v26
    v_sin_f32 v26, v26
    v_mul_f32 v24, v24, v32
    v_mul_f32 v26, v26, v32
    v_mul_f32 v33, 0x41000000, v17
    v_mul_f32 v27, 0x41000000, v19
    v_exp_f32 v33, v33
    v_fract_f32 v27, v27
    v_cos_f32 v25, v27
    v_sin_f32 v27, v27
    v_mul_f32 v25, v25, v33
    v_mul_f32 v27, v27, v33
    v_mov_b32 v28, 1.0
    v_mov_b32 v29, 1.0
    v_mov_b32 v30, 0
    v_mov_b32 v31, 0
    s_mov_b32 s66, 0
Lc_lgen:
    v_cvt_pk_bf16_f32 v40, v28, v30
    v_cvt_pk_bf16_f32 v41, v29, v31
    v_pk_mul_f32 v[32:33], v[30:31], v[26:27]
    v_pk_mul_f32 v[34:35], v[30:31], v[24:25]
    v_pk_fma_f32 v[30:31], v[28:29], v[26:27], v[34:35]
    v_pk_fma_f32 v[28:29], v[28:29], v[24:25], v[32:33] neg_lo:[0,0,1] neg_hi:[0,0,1]
    ds_write_b64 v3, v[40:41] offset:0
    v_cvt_pk_bf16_f32 v42, v28, v30
    v_cvt_pk_bf16_f32 v43, v29, v31
    v_pk_mul_f32 v[32:33], v[30:31], v[26:27]
    v_pk_mul_f32 v[34:35], v[30:31], v[24:25]
    v_pk_fma_f32 v[30:31], v[28:29], v[26:27], v[34:35]
    v_pk_fma_f32 v[28:29], v[28:29], v[24:25], v[32:33] neg_lo:[0,0,1] neg_hi:[0,0,1]
    ds_write_b64 v3, v[42:43] offset:528
    v_cvt_pk_bf16_f32 v44, v28, v30
    v_cvt_pk_bf16_f32 v45, v29, v31
    v_pk_mul_f32 v[32:33], v[30:31], v[26:27]
    v_pk_mul_f32 v[34:35], v[30:31], v[24:25]
    v_pk_fma_f32 v[30:31], v[28:29], v[26:27], v[34:35]
    v_pk_fma_f32 v[28:29], v[28:29], v[24:25], v[32:33] neg_lo:[0,0,1] neg_hi:[0,0,1]
    ds_write_b64 v3, v[44:45] offset:1056
    v_cvt_pk_bf16_f32 v46, v28, v30
    v_cvt_pk_bf16_f32 v47, v29, v31
    v_pk_mul_f32 v[32:33], v[30:31], v[26:27]
    v_pk_mul_f32 v[34:35], v[30:31], v[24:25]
    v_pk_fma_f32 v[30:31], v[28:29], v[26:27], v[34:35]
    v_pk_fma_f32 v[28:29], v[28:29], v[24:25], v[32:33] neg_lo:[0,0,1] neg_hi:[0,0,1]
    ds_write_b64 v3, v[46:47] offset:1584
    v_add_u32 v3, 2112, v3
    s_add_u32 s66, s66, 1
    s_cmp_lt_u32 s66, 8
    s_cbranch_scc1 Lc_lgen
    s_waitcnt vmcnt(0)
    v_and_b32 v4, 1, v1
    v_xor_b32 v4, 1, v4
    v_mul_u32_u24 v4, 4224, v4
    v_bfe_u32 v5, v1, 1, 1
    v_lshl_add_u32 v4, v5, 3, v4
    v_bfe_u32 v5, v1, 2, 2
    v_lshrrev_b32 v6, 4, v1
    v_add_u32 v5, v5, v6
    v_lshl_add_u32 v4, v5, 4, v4
    s_add_u32 s66, s12, 8
    v_add_u32 v4, s66, v4
    v_and_b32 v5, 1, v1
    v_mul_u32_u24 v5, 4576, v5
    v_bfe_u32 v7, v1, 1, 3
    v_lshlrev_b32 v8, 2, v7
    v_sub_u32 v8, v8, v6
    v_lshl_add_u32 v5, v8, 4, v5
    s_add_u32 s66, s12, 31648
    v_add_u32 v5, s66, v5
    v_mul_u32_u24 v8, 272, v6
    v_and_b32 v9, 15, v1
    v_lshl_add_u32 v8, v9, 4, v8
    v_add_u32 v8, s12, v8
    v_lshl_add_u32 v10, v1, 4, s12
    v_bfe_u32 v12, v1, 4, 1
    v_mul_u32_u24 v12, 4224, v12
    v_lshl_add_u32 v12, v9, 2, v12
    v_add_u32 v12, s12, v12
    v_mov_b32 v13, 0
    v_and_b32 v14, 1, v1
    v_cmp_eq_u32 vcc, 0, v14
    s_waitcnt lgkmcnt(0)
    s_barrier
    ds_read_b128 v[64:67], v23 offset:0
    ds_read_b128 v[68:71], v22 offset:0
    ds_read_b128 v[72:75], v23 offset:32
    ds_read_b128 v[76:79], v22 offset:32
    ds_read_b128 v[80:83], v23 offset:64
    ds_read_b128 v[84:87], v22 offset:64
    ds_read_b128 v[88:91], v23 offset:96
    ds_read_b128 v[92:95], v22 offset:96
    ds_read_b128 v[96:99], v23 offset:128
    ds_read_b128 v[100:103], v22 offset:128
    ds_read_b128 v[104:107], v23 offset:160
    ds_read_b128 v[108:111], v22 offset:160
    ds_read_b128 v[112:115], v23 offset:192
    ds_read_b128 v[116:119], v22 offset:192
    s_waitcnt lgkmcnt(12)
    v_mfma_f32_32x32x16_bf16 v[192:207], v[64:67], v[68:71], 0
    v_mov_b32 v24, 0
    v_mov_b32 v25, 0
    ds_read_b128 v[120:123], v23 offset:224
    ds_read_b128 v[124:127], v22 offset:224
    s_waitcnt lgkmcnt(12)
    v_mfma_f32_32x32x16_bf16 v[192:207], v[72:75], v[76:79], v[192:207]
    v_mov_b32 v26, 0
    v_mov_b32 v27, 0
    ds_read_b128 v[128:131], v23 offset:256
    ds_read_b128 v[132:135], v22 offset:256
    s_waitcnt lgkmcnt(12)
    v_mfma_f32_32x32x16_bf16 v[192:207], v[80:83], v[84:87], v[192:207]
    v_mov_b32 v28, 0
    v_mov_b32 v29, 0
    ds_read_b128 v[136:139], v23 offset:288
    ds_read_b128 v[140:143], v22 offset:288
    s_waitcnt lgkmcnt(12)
    v_mfma_f32_32x32x16_bf16 v[192:207], v[88:91], v[92:95], v[192:207]
    v_mov_b32 v30, 0
    v_mov_b32 v31, 0
    ds_read_b128 v[144:147], v23 offset:320
    ds_read_b128 v[148:151], v22 offset:320
    s_waitcnt lgkmcnt(12)
    v_mfma_f32_32x32x16_bf16 v[192:207], v[96:99], v[100:103], v[192:207]
    v_mov_b32 v32, 0
    v_mov_b32 v33, 0
    ds_read_b128 v[152:155], v23 offset:352
    ds_read_b128 v[156:159], v22 offset:352
    s_waitcnt lgkmcnt(12)
    v_mfma_f32_32x32x16_bf16 v[192:207], v[104:107], v[108:111], v[192:207]
    v_mov_b32 v34, 0
    v_mov_b32 v35, 0
    ds_read_b128 v[160:163], v23 offset:384
    ds_read_b128 v[164:167], v22 offset:384
    s_waitcnt lgkmcnt(12)
    v_mfma_f32_32x32x16_bf16 v[192:207], v[112:115], v[116:119], v[192:207]
    v_mov_b32 v36, 0
    v_mov_b32 v37, 0
    ds_read_b128 v[168:171], v23 offset:416
    ds_read_b128 v[172:175], v22 offset:416
    s_waitcnt lgkmcnt(12)
    v_mfma_f32_32x32x16_bf16 v[192:207], v[120:123], v[124:127], v[192:207]
    v_mov_b32 v38, 0
    v_mov_b32 v39, 0
    ds_read_b128 v[176:179], v23 offset:448
    ds_read_b128 v[180:183], v22 offset:448
    s_waitcnt lgkmcnt(12)
    v_mfma_f32_32x32x16_bf16 v[192:207], v[128:131], v[132:135], v[192:207]
    v_mov_b32 v40, 0
    v_mov_b32 v41, 0
    ds_read_b128 v[184:187], v23 offset:480
    ds_read_b128 v[188:191], v22 offset:480
    s_waitcnt lgkmcnt(12)
    v_mfma_f32_32x32x16_bf16 v[192:207], v[136:139], v[140:143], v[192:207]
    v_mov_b32 v42, 0
    v_mov_b32 v43, 0
    s_waitcnt lgkmcnt(10)
    v_mfma_f32_32x32x16_bf16 v[192:207], v[144:147], v[148:151], v[192:207]
    v_mov_b32 v44, 0
    v_mov_b32 v45, 0
    s_waitcnt lgkmcnt(8)
    v_mfma_f32_32x32x16_bf16 v[192:207], v[152:155], v[156:159], v[192:207]
    v_mov_b32 v46, 0
    v_mov_b32 v47, 0
    s_waitcnt lgkmcnt(6)
    v_mfma_f32_32x32x16_bf16 v[192:207], v[160:163], v[164:167], v[192:207]
    v_mov_b32 v48, 0
    v_mov_b32 v49, 0
    s_waitcnt lgkmcnt(4)
    v_mfma_f32_32x32x16_bf16 v[192:207], v[168:171], v[172:175], v[192:207]
    v_mov_b32 v50, 0
    v_mov_b32 v51, 0
    s_waitcnt lgkmcnt(2)
    v_mfma_f32_32x32x16_bf16 v[192:207], v[176:179], v[180:183], v[192:207]
    v_mov_b32 v52, 0
    v_mov_b32 v53, 0
    s_waitcnt lgkmcnt(0)
    v_mfma_f32_32x32x16_bf16 v[192:207], v[184:187], v[188:191], v[192:207]
    v_mov_b32 v54, 0
    v_mov_b32 v55, 0
    ds_write_b32 v12, v13
    s_nop 7
    s_nop 1
    v_cndmask_b32 v14, v205, v204, vcc
    v_cndmask_b32 v15, v207, v206, vcc
    v_cvt_pk_bf16_f32 v64, v192, v193
    v_cvt_pk_bf16_f32 v65, v194, v195
    v_cvt_pk_bf16_f32 v66, v196, v196
    v_cvt_pk_bf16_f32 v67, v197, v198
    v_cvt_pk_bf16_f32 v68, v200, v200
    v_cvt_pk_bf16_f32 v69, v200, v201
    v_cvt_pk_bf16_f32 v70, v201, v201
    v_cvt_pk_bf16_f32 v71, v202, v202
    v_permlane32_swap_b32 v64, v66
    v_permlane32_swap_b32 v65, v67
    ds_write_b128 v10, v[68:71] offset:1088
    ds_write_b128 v10, v[64:67] offset:64
    v_cvt_pk_bf16_f32 v72, v204, v204
    v_cvt_pk_bf16_f32 v73, v204, v204
    v_cvt_pk_bf16_f32 v74, v14, v205
    v_cvt_pk_bf16_f32 v75, v205, v205
    ds_write_b128 v10, v[72:75] offset:2112
    v_cvt_pk_bf16_f32 v76, v206, v206
    v_cvt_pk_bf16_f32 v77, v206, v206
    v_cvt_pk_bf16_f32 v78, v15, v207
    v_cvt_pk_bf16_f32 v79, v207, v207
    ds_write_b128 v10, v[76:79] offset:3136
    v_mov_b32 v80, 0
    v_mov_b32_dpp v84, v67 wave_ror:1 row_mask:0xf bank_mask:0xf
    v_mov_b32_dpp v88, v71 wave_ror:1 row_mask:0xf bank_mask:0xf
    v_mov_b32_dpp v92, v75 wave_ror:1 row_mask:0xf bank_mask:0xf
    v_mov_b32 v81, v64
    v_mov_b32 v82, v65
    v_mov_b32 v83, v66
    v_mov_b32_dpp v80, v67 wave_shr:1 row_mask:0xf bank_mask:0xf
    ds_write_b128 v10, v[80:83] offset:4288
    v_mov_b32 v85, v68
    v_mov_b32 v86, v69
    v_mov_b32 v87, v70
    v_mov_b32_dpp v84, v71 wave_shr:1 row_mask:0xf bank_mask:0xf
    ds_write_b128 v10, v[84:87] offset:5312
    v_mov_b32 v89, v72
    v_mov_b32 v90, v73
    v_mov_b32 v91, v74
    v_mov_b32_dpp v88, v75 wave_shr:1 row_mask:0xf bank_mask:0xf
    ds_write_b128 v10, v[88:91] offset:6336
    v_mov_b32 v93, v76
    v_mov_b32 v94, v77
    v_mov_b32 v95, v78
    v_mov_b32_dpp v92, v79 wave_shr:1 row_mask:0xf bank_mask:0xf
    ds_write_b128 v10, v[92:95] offset:7360
    s_waitcnt lgkmcnt(0)
    s_barrier
    ds_read_b128 v[96:99], v5 offset:0
    ds_read_b64 v[64:65], v4 offset:0
    ds_read_b64 v[66:67], v4 offset:8
    ds_read_b128 v[100:103], v5 offset:512
    ds_read_b64 v[68:69], v4 offset:512
    ds_read_b64 v[70:71], v4 offset:520
    ds_read_b128 v[104:107], v5 offset:1024
    ds_read_b64 v[72:73], v4 offset:1024
    ds_read_b64 v[74:75], v4 offset:1032
    ds_read_b128 v[108:111], v5 offset:1536
    ds_read_b64 v[76:77], v4 offset:1536
    ds_read_b64 v[78:79], v4 offset:1544
    ds_read_b128 v[112:115], v5 offset:2048
    ds_read_b64 v[80:81], v4 offset:2048
    ds_read_b64 v[82:83], v4 offset:2056
    ds_read_b128 v[116:119], v5 offset:2560
    ds_read_b64 v[84:85], v4 offset:2560
    ds_read_b64 v[86:87], v4 offset:2568
    ds_read_b128 v[120:123], v5 offset:3072
    ds_read_b64 v[88:89], v4 offset:3072
    ds_read_b64 v[90:91], v4 offset:3080
    ds_read_b128 v[124:127], v5 offset:3584
    ds_read_b64 v[92:93], v4 offset:3584
    ds_read_b64 v[94:95], v4 offset:3592
    v_add_u32 v4, 64, v4
    v_subrev_u32 v5, 64, v5
    s_mov_b32 s66, 0
Lc_loop:
    s_waitcnt lgkmcnt(0)
    v_mfma_f32_16x16x32_bf16 v[24:27], v[64:67], v[96:99], v[24:27]
    ds_read_b128 v[160:163], v5 offset:0
    v_mfma_f32_16x16x32_bf16 v[28:31], v[64:67], v[100:103], v[28:31]
    ds_read_b64 v[128:129], v4 offset:0
    v_mfma_f32_16x16x32_bf16 v[32:35], v[64:67], v[104:107], v[32:35]
    ds_read_b64 v[130:131], v4 offset:8
    v_mfma_f32_16x16x32_bf16 v[36:39], v[64:67], v[108:111], v[36:39]
    ds_read_b128 v[164:167], v5 offset:512
    v_mfma_f32_16x16x32_bf16 v[40:43], v[64:67], v[112:115], v[40:43]
    ds_read_b64 v[132:133], v4 offset:512
    v_mfma_f32_16x16x32_bf16 v[44:47], v[64:67], v[116:119], v[44:47]
    ds_read_b64 v[134:135], v4 offset:520
    v_mfma_f32_16x16x32_bf16 v[48:51], v[64:67], v[120:123], v[48:51]
    ds_read_b128 v[168:171], v5 offset:1024
    v_mfma_f32_16x16x32_bf16 v[52:55], v[64:67], v[124:127], v[52:55]
    ds_read_b64 v[136:137], v4 offset:1024
    v_mfma_f32_16x16x32_bf16 v[28:31], v[68:71], v[96:99], v[28:31]
    ds_read_b64 v[138:139], v4 offset:1032
    v_mfma_f32_16x16x32_bf16 v[32:35], v[68:71], v[100:103], v[32:35]
    ds_read_b128 v[172:175], v5 offset:1536
    v_mfma_f32_16x16x32_bf16 v[36:39], v[68:71], v[104:107], v[36:39]
    ds_read_b64 v[140:141], v4 offset:1536
    v_mfma_f32_16x16x32_bf16 v[40:43], v[68:71], v[108:111], v[40:43]
    ds_read_b64 v[142:143], v4 offset:1544
    v_mfma_f32_16x16x32_bf16 v[44:47], v[68:71], v[112:115], v[44:47]
    ds_read_b128 v[176:179], v5 offset:2048
    v_mfma_f32_16x16x32_bf16 v[48:51], v[68:71], v[116:119], v[48:51]
    ds_read_b64 v[144:145], v4 offset:2048
    v_mfma_f32_16x16x32_bf16 v[52:55], v[68:71], v[120:123], v[52:55]
    ds_read_b64 v[146:147], v4 offset:2056
    v_mfma_f32_16x16x32_bf16 v[32:35], v[72:75], v[96:99], v[32:35]
    ds_read_b128 v[180:183], v5 offset:2560
    v_mfma_f32_16x16x32_bf16 v[36:39], v[72:75], v[100:103], v[36:39]
    ds_read_b64 v[148:149], v4 offset:2560
    v_mfma_f32_16x16x32_bf16 v[40:43], v[72:75], v[104:107], v[40:43]
    ds_read_b64 v[150:151], v4 offset:2568
    v_mfma_f32_16x16x32_bf16 v[44:47], v[72:75], v[108:111], v[44:47]
    ds_read_b128 v[184:187], v5 offset:3072
    v_mfma_f32_16x16x32_bf16 v[48:51], v[72:75], v[112:115], v[48:51]
    ds_read_b64 v[152:153], v4 offset:3072
    v_mfma_f32_16x16x32_bf16 v[52:55], v[72:75], v[116:119], v[52:55]
    ds_read_b64 v[154:155], v4 offset:3080
    v_mfma_f32_16x16x32_bf16 v[36:39], v[76:79], v[96:99], v[36:39]
    ds_read_b128 v[188:191], v5 offset:3584
    v_mfma_f32_16x16x32_bf16 v[40:43], v[76:79], v[100:103], v[40:43]
    ds_read_b64 v[156:157], v4 offset:3584
    v_mfma_f32_16x16x32_bf16 v[44:47], v[76:79], v[104:107], v[44:47]
    ds_read_b64 v[158:159], v4 offset:3592
    v_mfma_f32_16x16x32_bf16 v[48:51], v[76:79], v[108:111], v[48:51]
    v_add_u32 v4, 64, v4
    v_mfma_f32_16x16x32_bf16 v[52:55], v[76:79], v[112:115], v[52:55]
    v_subrev_u32 v5, 64, v5
    v_mfma_f32_16x16x32_bf16 v[40:43], v[80:83], v[96:99], v[40:43]
    v_mfma_f32_16x16x32_bf16 v[44:47], v[80:83], v[100:103], v[44:47]
    v_mfma_f32_16x16x32_bf16 v[48:51], v[80:83], v[104:107], v[48:51]
    v_mfma_f32_16x16x32_bf16 v[52:55], v[80:83], v[108:111], v[52:55]
    v_mfma_f32_16x16x32_bf16 v[44:47], v[84:87], v[96:99], v[44:47]
    v_mfma_f32_16x16x32_bf16 v[48:51], v[84:87], v[100:103], v[48:51]
    v_mfma_f32_16x16x32_bf16 v[52:55], v[84:87], v[104:107], v[52:55]
    v_mfma_f32_16x16x32_bf16 v[48:51], v[88:91], v[96:99], v[48:51]
    v_mfma_f32_16x16x32_bf16 v[52:55], v[88:91], v[100:103], v[52:55]
    v_mfma_f32_16x16x32_bf16 v[52:55], v[92:95], v[96:99], v[52:55]
    s_waitcnt lgkmcnt(0)
    v_mfma_f32_16x16x32_bf16 v[24:27], v[128:131], v[160:163], v[24:27]
    ds_read_b128 v[96:99], v5 offset:0
    v_mfma_f32_16x16x32_bf16 v[28:31], v[128:131], v[164:167], v[28:31]
    ds_read_b64 v[64:65], v4 offset:0
    v_mfma_f32_16x16x32_bf16 v[32:35], v[128:131], v[168:171], v[32:35]
    ds_read_b64 v[66:67], v4 offset:8
    v_mfma_f32_16x16x32_bf16 v[36:39], v[128:131], v[172:175], v[36:39]
    ds_read_b128 v[100:103], v5 offset:512
    v_mfma_f32_16x16x32_bf16 v[40:43], v[128:131], v[176:179], v[40:43]
    ds_read_b64 v[68:69], v4 offset:512
    v_mfma_f32_16x16x32_bf16 v[44:47], v[128:131], v[180:183], v[44:47]
    ds_read_b64 v[70:71], v4 offset:520
    v_mfma_f32_16x16x32_bf16 v[48:51], v[128:131], v[184:187], v[48:51]
    ds_read_b128 v[104:107], v5 offset:1024
    v_mfma_f32_16x16x32_bf16 v[52:55], v[128:131], v[188:191], v[52:55]
    ds_read_b64 v[72:73], v4 offset:1024
    v_mfma_f32_16x16x32_bf16 v[28:31], v[132:135], v[160:163], v[28:31]
    ds_read_b64 v[74:75], v4 offset:1032
    v_mfma_f32_16x16x32_bf16 v[32:35], v[132:135], v[164:167], v[32:35]
    ds_read_b128 v[108:111], v5 offset:1536
    v_mfma_f32_16x16x32_bf16 v[36:39], v[132:135], v[168:171], v[36:39]
    ds_read_b64 v[76:77], v4 offset:1536
    v_mfma_f32_16x16x32_bf16 v[40:43], v[132:135], v[172:175], v[40:43]
    ds_read_b64 v[78:79], v4 offset:1544
    v_mfma_f32_16x16x32_bf16 v[44:47], v[132:135], v[176:179], v[44:47]
    ds_read_b128 v[112:115], v5 offset:2048
    v_mfma_f32_16x16x32_bf16 v[48:51], v[132:135], v[180:183], v[48:51]
    ds_read_b64 v[80:81], v4 offset:2048
    v_mfma_f32_16x16x32_bf16 v[52:55], v[132:135], v[184:187], v[52:55]
    ds_read_b64 v[82:83], v4 offset:2056
    v_mfma_f32_16x16x32_bf16 v[32:35], v[136:139], v[160:163], v[32:35]
    ds_read_b128 v[116:119], v5 offset:2560
    v_mfma_f32_16x16x32_bf16 v[36:39], v[136:139], v[164:167], v[36:39]
    ds_read_b64 v[84:85], v4 offset:2560
    v_mfma_f32_16x16x32_bf16 v[40:43], v[136:139], v[168:171], v[40:43]
    ds_read_b64 v[86:87], v4 offset:2568
    v_mfma_f32_16x16x32_bf16 v[44:47], v[136:139], v[172:175], v[44:47]
    ds_read_b128 v[120:123], v5 offset:3072
    v_mfma_f32_16x16x32_bf16 v[48:51], v[136:139], v[176:179], v[48:51]
    ds_read_b64 v[88:89], v4 offset:3072
    v_mfma_f32_16x16x32_bf16 v[52:55], v[136:139], v[180:183], v[52:55]
    ds_read_b64 v[90:91], v4 offset:3080
    v_mfma_f32_16x16x32_bf16 v[36:39], v[140:143], v[160:163], v[36:39]
    ds_read_b128 v[124:127], v5 offset:3584
    v_mfma_f32_16x16x32_bf16 v[40:43], v[140:143], v[164:167], v[40:43]
    ds_read_b64 v[92:93], v4 offset:3584
    v_mfma_f32_16x16x32_bf16 v[44:47], v[140:143], v[168:171], v[44:47]
    ds_read_b64 v[94:95], v4 offset:3592
    v_mfma_f32_16x16x32_bf16 v[48:51], v[140:143], v[172:175], v[48:51]
    v_add_u32 v4, 64, v4
    v_mfma_f32_16x16x32_bf16 v[52:55], v[140:143], v[176:179], v[52:55]
    v_subrev_u32 v5, 64, v5
    v_mfma_f32_16x16x32_bf16 v[40:43], v[144:147], v[160:163], v[40:43]
    s_add_u32 s66, s66, 1
    v_mfma_f32_16x16x32_bf16 v[44:47], v[144:147], v[164:167], v[44:47]
    s_cmp_lt_u32 s66, 4
    v_mfma_f32_16x16x32_bf16 v[48:51], v[144:147], v[168:171], v[48:51]
    v_mfma_f32_16x16x32_bf16 v[52:55], v[144:147], v[172:175], v[52:55]
    v_mfma_f32_16x16x32_bf16 v[44:47], v[148:151], v[160:163], v[44:47]
    v_mfma_f32_16x16x32_bf16 v[48:51], v[148:151], v[164:167], v[48:51]
    v_mfma_f32_16x16x32_bf16 v[52:55], v[148:151], v[168:171], v[52:55]
    v_mfma_f32_16x16x32_bf16 v[48:51], v[152:155], v[160:163], v[48:51]
    v_mfma_f32_16x16x32_bf16 v[52:55], v[152:155], v[164:167], v[52:55]
    v_mfma_f32_16x16x32_bf16 v[52:55], v[156:159], v[160:163], v[52:55]
    s_cbranch_scc1 Lc_loop
    s_waitcnt lgkmcnt(0)
    ds_write_b128 v8, v[24:27] offset:0
    ds_write_b128 v8, v[28:31] offset:1088
    ds_write_b128 v8, v[32:35] offset:2176
    ds_write_b128 v8, v[36:39] offset:3264
    ds_write_b128 v8, v[40:43] offset:4352
    ds_write_b128 v8, v[44:47] offset:5440
    s_nop 1
    ds_write_b128 v8, v[48:51] offset:6528
    ds_write_b128 v8, v[52:55] offset:7616
    v_mov_b32 v4, 0
    global_load_dword v4, v4, s[44:45]
    s_waitcnt lgkmcnt(0)
    s_barrier
    s_mul_i32 s90, s3, 40960
    s_lshl_b32 s8, s5, 2
    s_add_u32 s8, s8, s3
    s_cmp_ge_u32 s8, 28
    s_cselect_b32 s9, 1, 0
    s_mul_i32 s10, s9, 28
    s_sub_u32 s10, s8, s10
    s_lshl_b32 s11, s4, 1
    s_add_u32 s9, s9, s11
    s_lshl_b32 s11, s9, 5
    s_add_u32 s11, s11, s10
    s_lshl_b32 s11, s11, 7
    s_add_u32 s11, s11, 11288576
    s_mul_i32 s9, s9, 458752
    s_lshl_b32 s10, s10, 12
    s_add_u32 s9, s9, s10
    s_add_u32 s10, s9, 229376
    v_mov_b32 v5, s11
    v_and_b32 v6, 31, v1
    v_lshlrev_b32 v6, 7, v6
    v_lshrrev_b32 v7, 5, v1
    v_mul_u32_u24 v7, 114688, v7
    v_add_u32 v6, v6, v7
    s_waitcnt vmcnt(0)
    v_readfirstlane_b32 s79, v4
    s_ff1_i32_b32 s79, s79
    s_cmp_ge_i32 s79, 4
    s_cbranch_scc1 Ltag2
    s_mov_b32 s76, 40000
    v_mov_b32 v20, 0
Ltag2p:
    global_load_dword v4, v20, s[44:45] sc1
    s_sub_u32 s76, s76, 1
    s_waitcnt vmcnt(0)
    v_readfirstlane_b32 s79, v4
    s_ff1_i32_b32 s79, s79
    s_cmp_ge_i32 s79, 4
    s_cbranch_scc1 Ltag2
    s_sleep 12
    s_cmp_lg_u32 s76, 0
    s_cbranch_scc1 Ltag2p
Ltag2:
    s_mov_b32 s79, 16
    s_branch Lp2_aux
Lc_rwave:
    s_waitcnt vmcnt(1)
    v_add_f32 v13, v13, v13
    v_lshlrev_b32 v64, 16, v6
    v_and_b32 v65, 0xffff0000, v6
    v_lshlrev_b32 v66, 16, v7
    v_and_b32 v67, 0xffff0000, v7
    s_mov_b64 exec, 1
    buffer_load_dwordx2 v[46:47], v10, s[48:51], 0 offen
    s_mov_b64 exec, -1
    buffer_load_dwordx2 v[48:49], v9, s[48:51], 0 offen offset:0
    v_exp_f32 v32, v16
    v_fract_f32 v26, v18
    v_cos_f32 v24, v26
    v_sin_f32 v26, v26
    v_mul_f32 v24, v24, v32
    v_mul_f32 v26, v26, v32
    v_exp_f32 v33, v17
    v_fract_f32 v27, v19
    v_cos_f32 v25, v27
    v_sin_f32 v27, v27
    v_mul_f32 v25, v25, v33
    v_mul_f32 v27, v27, v33
    v_mul_f32 v32, 0x43800000, v16
    v_mul_f32 v30, 0x43800000, v18
    v_exp_f32 v32, v32
    v_fract_f32 v30, v30
    v_cos_f32 v28, v30
    v_sin_f32 v30, v30
    v_mul_f32 v28, v28, v32
    v_mul_f32 v30, v30, v32
    v_mul_f32 v33, 0x43800000, v17
    v_mul_f32 v31, 0x43800000, v19
    v_exp_f32 v33, v33
    v_fract_f32 v31, v31
    v_cos_f32 v29, v31
    v_sin_f32 v31, v31
    v_mul_f32 v29, v29, v33
    v_mul_f32 v31, v31, v33
    v_mul_f32 v64, v64, v13
    v_mul_f32 v65, v65, v13
    v_mul_f32 v66, v66, v13
    v_mul_f32 v67, v67, v13
    v_cvt_pk_bf16_f32 v88, v64, -v66
    v_cvt_pk_bf16_f32 v89, v65, -v67
    ds_write_b64 v3, v[88:89] offset:16896
    v_pk_mul_f32 v[32:33], v[66:67], v[26:27]
    v_pk_mul_f32 v[34:35], v[66:67], v[24:25]
    v_pk_fma_f32 v[86:87], v[64:65], v[26:27], v[34:35]
    v_pk_fma_f32 v[84:85], v[64:65], v[24:25], v[32:33] neg_lo:[0,0,1] neg_hi:[0,0,1]
    v_cvt_pk_bf16_f32 v90, v84, -v86
    v_cvt_pk_bf16_f32 v91, v85, -v87
    ds_write_b64 v3, v[90:91] offset:17424
    v_pk_mul_f32 v[32:33], v[86:87], v[26:27]
    v_pk_mul_f32 v[34:35], v[86:87], v[24:25]
    v_pk_fma_f32 v[70:71], v[84:85], v[26:27], v[34:35]
    v_pk_fma_f32 v[68:69], v[84:85], v[24:25], v[32:33] neg_lo:[0,0,1] neg_hi:[0,0,1]
    v_cvt_pk_bf16_f32 v92, v68, -v70
    v_cvt_pk_bf16_f32 v93, v69, -v71
    ds_write_b64 v3, v[92:93] offset:17952
    buffer_load_dwordx2 v[50:51], v9, s[48:51], 0 offen offset:1024
    v_pk_mul_f32 v[32:33], v[70:71], v[26:27]
    v_pk_mul_f32 v[34:35], v[70:71], v[24:25]
    v_pk_fma_f32 v[86:87], v[68:69], v[26:27], v[34:35]
    v_pk_fma_f32 v[84:85], v[68:69], v[24:25], v[32:33] neg_lo:[0,0,1] neg_hi:[0,0,1]
    v_cvt_pk_bf16_f32 v94, v84, -v86
    v_cvt_pk_bf16_f32 v95, v85, -v87
    ds_write_b64 v3, v[94:95] offset:18480
    v_pk_mul_f32 v[32:33], v[86:87], v[26:27]
    v_pk_mul_f32 v[34:35], v[86:87], v[24:25]
    v_pk_fma_f32 v[74:75], v[84:85], v[26:27], v[34:35]
    v_pk_fma_f32 v[72:73], v[84:85], v[24:25], v[32:33] neg_lo:[0,0,1] neg_hi:[0,0,1]
    v_cvt_pk_bf16_f32 v88, v72, -v74
    v_cvt_pk_bf16_f32 v89, v73, -v75
    ds_write_b64 v3, v[88:89] offset:19008
    v_pk_mul_f32 v[32:33], v[74:75], v[26:27]
    v_pk_mul_f32 v[34:35], v[74:75], v[24:25]
    v_pk_fma_f32 v[86:87], v[72:73], v[26:27], v[34:35]
    v_pk_fma_f32 v[84:85], v[72:73], v[24:25], v[32:33] neg_lo:[0,0,1] neg_hi:[0,0,1]
    v_cvt_pk_bf16_f32 v90, v84, -v86
    v_cvt_pk_bf16_f32 v91, v85, -v87
    ds_write_b64 v3, v[90:91] offset:19536
    v_pk_mul_f32 v[32:33], v[86:87], v[26:27]
    v_pk_mul_f32 v[34:35], v[86:87], v[24:25]
    v_pk_fma_f32 v[78:79], v[84:85], v[26:27], v[34:35]
    v_pk_fma_f32 v[76:77], v[84:85], v[24:25], v[32:33] neg_lo:[0,0,1] neg_hi:[0,0,1]
    v_cvt_pk_bf16_f32 v92, v76, -v78
    v_cvt_pk_bf16_f32 v93, v77, -v79
    ds_write_b64 v3, v[92:93] offset:20064
    v_pk_mul_f32 v[32:33], v[78:79], v[26:27]
    v_pk_mul_f32 v[34:35], v[78:79], v[24:25]
    v_pk_fma_f32 v[86:87], v[76:77], v[26:27], v[34:35]
    v_pk_fma_f32 v[84:85], v[76:77], v[24:25], v[32:33] neg_lo:[0,0,1] neg_hi:[0,0,1]
    v_cvt_pk_bf16_f32 v94, v84, -v86
    v_cvt_pk_bf16_f32 v95, v85, -v87
    ds_write_b64 v3, v[94:95] offset:20592
    v_pk_mul_f32 v[32:33], v[86:87], v[26:27]
    v_pk_mul_f32 v[34:35], v[86:87], v[24:25]
    v_pk_fma_f32 v[82:83], v[84:85], v[26:27], v[34:35]
    v_pk_fma_f32 v[80:81], v[84:85], v[24:25], v[32:33] neg_lo:[0,0,1] neg_hi:[0,0,1]
    v_pk_mul_f32 v[32:33], v[66:67], v[30:31]
    v_pk_mul_f32 v[34:35], v[66:67], v[28:29]
    v_pk_fma_f32 v[66:67], v[64:65], v[30:31], v[34:35]
    v_pk_fma_f32 v[64:65], v[64:65], v[28:29], v[32:33] neg_lo:[0,0,1] neg_hi:[0,0,1]
    v_cvt_pk_bf16_f32 v88, v64, -v66
    v_cvt_pk_bf16_f32 v89, v65, -v67
    ds_write_b64 v3, v[88:89] offset:21120
    v_pk_mul_f32 v[32:33], v[70:71], v[30:31]
    v_pk_mul_f32 v[34:35], v[70:71], v[28:29]
    v_pk_fma_f32 v[70:71], v[68:69], v[30:31], v[34:35]
    v_pk_fma_f32 v[68:69], v[68:69], v[28:29], v[32:33] neg_lo:[0,0,1] neg_hi:[0,0,1]
    v_cvt_pk_bf16_f32 v90, v68, -v70
    v_cvt_pk_bf16_f32 v91, v69, -v71
    ds_write_b64 v3, v[90:91] offset:21648
    v_pk_mul_f32 v[32:33], v[74:75], v[30:31]
    v_pk_mul_f32 v[34:35], v[74:75], v[28:29]
    v_pk_fma_f32 v[74:75], v[72:73], v[30:31], v[34:35]
    v_pk_fma_f32 v[72:73], v[72:73], v[28:29], v[32:33] neg_lo:[0,0,1] neg_hi:[0,0,1]
    v_cvt_pk_bf16_f32 v92, v72, -v74
    v_cvt_pk_bf16_f32 v93, v73, -v75
    ds_write_b64 v3, v[92:93] offset:22176
    buffer_load_dwordx2 v[52:53], v9, s[48:51], 0 offen offset:2048
    v_pk_mul_f32 v[32:33], v[78:79], v[30:31]
    v_pk_mul_f32 v[34:35], v[78:79], v[28:29]
    v_pk_fma_f32 v[78:79], v[76:77], v[30:31], v[34:35]
    v_pk_fma_f32 v[76:77], v[76:77], v[28:29], v[32:33] neg_lo:[0,0,1] neg_hi:[0,0,1]
    v_cvt_pk_bf16_f32 v94, v76, -v78
    v_cvt_pk_bf16_f32 v95, v77, -v79
    ds_write_b64 v3, v[94:95] offset:22704
    v_pk_mul_f32 v[32:33], v[82:83], v[30:31]
    v_pk_mul_f32 v[34:35], v[82:83], v[28:29]
    v_pk_fma_f32 v[82:83], v[80:81], v[30:31], v[34:35]
    v_pk_fma_f32 v[80:81], v[80:81], v[28:29], v[32:33] neg_lo:[0,0,1] neg_hi:[0,0,1]
    v_cvt_pk_bf16_f32 v88, v80, -v82
    v_cvt_pk_bf16_f32 v89, v81, -v83
    ds_write_b64 v3, v[88:89] offset:23232
    v_pk_mul_f32 v[32:33], v[66:67], v[30:31]
    v_pk_mul_f32 v[34:35], v[66:67], v[28:29]
    v_pk_fma_f32 v[66:67], v[64:65], v[30:31], v[34:35]
    v_pk_fma_f32 v[64:65], v[64:65], v[28:29], v[32:33] neg_lo:[0,0,1] neg_hi:[0,0,1]
    v_cvt_pk_bf16_f32 v90, v64, -v66
    v_cvt_pk_bf16_f32 v91, v65, -v67
    ds_write_b64 v3, v[90:91] offset:23760
    v_pk_mul_f32 v[32:33], v[74:75], v[30:31]
    v_pk_mul_f32 v[34:35], v[74:75], v[28:29]
    v_pk_fma_f32 v[74:75], v[72:73], v[30:31], v[34:35]
    v_pk_fma_f32 v[72:73], v[72:73], v[28:29], v[32:33] neg_lo:[0,0,1] neg_hi:[0,0,1]
    v_cvt_pk_bf16_f32 v92, v72, -v74
    v_cvt_pk_bf16_f32 v93, v73, -v75
    ds_write_b64 v3, v[92:93] offset:24288
    v_pk_mul_f32 v[32:33], v[82:83], v[30:31]
    v_pk_mul_f32 v[34:35], v[82:83], v[28:29]
    v_pk_fma_f32 v[82:83], v[80:81], v[30:31], v[34:35]
    v_pk_fma_f32 v[80:81], v[80:81], v[28:29], v[32:33] neg_lo:[0,0,1] neg_hi:[0,0,1]
    v_cvt_pk_bf16_f32 v94, v80, -v82
    v_cvt_pk_bf16_f32 v95, v81, -v83
    ds_write_b64 v3, v[94:95] offset:24816
    v_pk_mul_f32 v[32:33], v[66:67], v[30:31]
    v_pk_mul_f32 v[34:35], v[66:67], v[28:29]
    v_pk_fma_f32 v[66:67], v[64:65], v[30:31], v[34:35]
    v_pk_fma_f32 v[64:65], v[64:65], v[28:29], v[32:33] neg_lo:[0,0,1] neg_hi:[0,0,1]
    v_cvt_pk_bf16_f32 v88, v64, -v66
    v_cvt_pk_bf16_f32 v89, v65, -v67
    ds_write_b64 v3, v[88:89] offset:25344
    v_pk_mul_f32 v[32:33], v[74:75], v[30:31]
    v_pk_mul_f32 v[34:35], v[74:75], v[28:29]
    v_pk_fma_f32 v[74:75], v[72:73], v[30:31], v[34:35]
    v_pk_fma_f32 v[72:73], v[72:73], v[28:29], v[32:33] neg_lo:[0,0,1] neg_hi:[0,0,1]
    v_cvt_pk_bf16_f32 v90, v72, -v74
    v_cvt_pk_bf16_f32 v91, v73, -v75
    ds_write_b64 v3, v[90:91] offset:25872
    v_pk_mul_f32 v[32:33], v[82:83], v[30:31]
    v_pk_mul_f32 v[34:35], v[82:83], v[28:29]
    v_pk_fma_f32 v[82:83], v[80:81], v[30:31], v[34:35]
    v_pk_fma_f32 v[80:81], v[80:81], v[28:29], v[32:33] neg_lo:[0,0,1] neg_hi:[0,0,1]
    v_cvt_pk_bf16_f32 v92, v80, -v82
    v_cvt_pk_bf16_f32 v93, v81, -v83
    ds_write_b64 v3, v[92:93] offset:26400
    buffer_load_dwordx2 v[54:55], v9, s[48:51], 0 offen offset:3072
    v_pk_mul_f32 v[32:33], v[66:67], v[30:31]
    v_pk_mul_f32 v[34:35], v[66:67], v[28:29]
    v_pk_fma_f32 v[66:67], v[64:65], v[30:31], v[34:35]
    v_pk_fma_f32 v[64:65], v[64:65], v[28:29], v[32:33] neg_lo:[0,0,1] neg_hi:[0,0,1]
    v_cvt_pk_bf16_f32 v94, v64, -v66
    v_cvt_pk_bf16_f32 v95, v65, -v67
    ds_write_b64 v3, v[94:95] offset:26928
    v_pk_mul_f32 v[32:33], v[82:83], v[30:31]
    v_pk_mul_f32 v[34:35], v[82:83], v[28:29]
    v_pk_fma_f32 v[82:83], v[80:81], v[30:31], v[34:35]
    v_pk_fma_f32 v[80:81], v[80:81], v[28:29], v[32:33] neg_lo:[0,0,1] neg_hi:[0,0,1]
    v_cvt_pk_bf16_f32 v88, v80, -v82
    v_cvt_pk_bf16_f32 v89, v81, -v83
    ds_write_b64 v3, v[88:89] offset:27456
    v_pk_mul_f32 v[32:33], v[66:67], v[30:31]
    v_pk_mul_f32 v[34:35], v[66:67], v[28:29]
    v_pk_fma_f32 v[66:67], v[64:65], v[30:31], v[34:35]
    v_pk_fma_f32 v[64:65], v[64:65], v[28:29], v[32:33] neg_lo:[0,0,1] neg_hi:[0,0,1]
    v_cvt_pk_bf16_f32 v90, v64, -v66
    v_cvt_pk_bf16_f32 v91, v65, -v67
    ds_write_b64 v3, v[90:91] offset:29040
    v_pk_mul_f32 v[32:33], v[82:83], v[30:31]
    v_pk_mul_f32 v[34:35], v[82:83], v[28:29]
    v_pk_fma_f32 v[82:83], v[80:81], v[30:31], v[34:35]
    v_pk_fma_f32 v[80:81], v[80:81], v[28:29], v[32:33] neg_lo:[0,0,1] neg_hi:[0,0,1]
    v_cvt_pk_bf16_f32 v92, v80, -v82
    v_cvt_pk_bf16_f32 v93, v81, -v83
    ds_write_b64 v3, v[92:93] offset:29568
    v_pk_mul_f32 v[32:33], v[66:67], v[30:31]
    v_pk_mul_f32 v[34:35], v[66:67], v[28:29]
    v_pk_fma_f32 v[66:67], v[64:65], v[30:31], v[34:35]
    v_pk_fma_f32 v[64:65], v[64:65], v[28:29], v[32:33] neg_lo:[0,0,1] neg_hi:[0,0,1]
    v_cvt_pk_bf16_f32 v94, v64, -v66
    v_cvt_pk_bf16_f32 v95, v65, -v67
    ds_write_b64 v3, v[94:95] offset:27984
    v_pk_mul_f32 v[32:33], v[82:83], v[30:31]
    v_pk_mul_f32 v[34:35], v[82:83], v[28:29]
    v_pk_fma_f32 v[82:83], v[80:81], v[30:31], v[34:35]
    v_pk_fma_f32 v[80:81], v[80:81], v[28:29], v[32:33] neg_lo:[0,0,1] neg_hi:[0,0,1]
    v_cvt_pk_bf16_f32 v88, v80, -v82
    v_cvt_pk_bf16_f32 v89, v81, -v83
    ds_write_b64 v3, v[88:89] offset:28512
    v_pk_mul_f32 v[32:33], v[66:67], v[30:31]
    v_pk_mul_f32 v[34:35], v[66:67], v[28:29]
    v_pk_fma_f32 v[66:67], v[64:65], v[30:31], v[34:35]
    v_pk_fma_f32 v[64:65], v[64:65], v[28:29], v[32:33] neg_lo:[0,0,1] neg_hi:[0,0,1]
    v_cvt_pk_bf16_f32 v90, v64, -v66
    v_cvt_pk_bf16_f32 v91, v65, -v67
    ds_write_b64 v3, v[90:91] offset:30096
    v_pk_mul_f32 v[32:33], v[82:83], v[30:31]
    v_pk_mul_f32 v[34:35], v[82:83], v[28:29]
    v_pk_fma_f32 v[82:83], v[80:81], v[30:31], v[34:35]
    v_pk_fma_f32 v[80:81], v[80:81], v[28:29], v[32:33] neg_lo:[0,0,1] neg_hi:[0,0,1]
    v_cvt_pk_bf16_f32 v92, v80, -v82
    v_cvt_pk_bf16_f32 v93, v81, -v83
    ds_write_b64 v3, v[92:93] offset:30624
    buffer_load_dwordx2 v[56:57], v9, s[48:51], s64 offen offset:0
    s_waitcnt lgkmcnt(0)
    s_barrier
    buffer_load_dwordx2 v[58:59], v9, s[48:51], s64 offen offset:1024
    buffer_load_dwordx2 v[60:61], v9, s[48:51], s64 offen offset:2048
    buffer_load_dwordx2 v[62:63], v9, s[48:51], s64 offen offset:3072
    s_mov_b32 s66, 0x05040100
    s_mov_b32 s67, 0x07060302
    v_bfe_u32 v4, v8, 5, 1
    v_mul_u32_u24 v4, 4576, v4
    v_add_u32 v4, s12, v4
    v_and_b32 v5, 31, v8
    v_min_u32 v5, 27, v5
    v_lshl_add_u32 v4, v5, 4, v4
    v_mov_b32 v24, 0
    v_mov_b32 v25, 0
    v_mov_b32 v26, 0
    v_mov_b32 v27, 0
    v_add_u32 v4, 31152, v4
    ds_write_b128 v4, v[24:27]
    v_lshlrev_b32 v4, 4, v8
    v_add_u32 v4, 31600, v4
    v_add_u32 v5, 81920, v4
    s_sub_u32 s77, s3, 4
    s_bfe_u32 s76, s97, 0x30003
    s_mul_i32 s91, s77, 458752
    s_lshl_b32 s80, s76, 7
    s_add_u32 s91, s91, s80
    v_lshrrev_b32 v44, 3, v1
    v_lshlrev_b32 v44, 10, v44
    v_bfe_u32 v45, v1, 4, 1
    v_lshlrev_b32 v45, 2, v45
    v_and_b32 v6, 7, v1
    v_xor_b32 v45, v45, v6
    v_lshl_add_u32 v44, v45, 4, v44
    v_add_u32 v44, s91, v44
    v_add_u32 v45, 0x2000, v44
    s_lshr_b32 s80, s97, 6
    s_lshl_b32 s80, s80, 1
    s_add_u32 s80, s80, s76
    s_cmp_ge_u32 s80, 7
    s_cselect_b32 s81, 7, 0
    s_sub_u32 s80, s80, s81
    s_lshl_b32 s80, s80, 12
    s_add_u32 s81, s80, 4096
    s_cmp_eq_u32 s81, 28672
    s_cselect_b32 s81, 0, s81
    s_add_u32 s82, s81, 4096
    s_cmp_eq_u32 s82, 28672
    s_cselect_b32 s82, 0, s82
    s_add_u32 s83, s82, 4096
    s_cmp_eq_u32 s83, 28672
    s_cselect_b32 s83, 0, s83
    s_add_u32 s84, s83, 4096
    s_cmp_eq_u32 s84, 28672
    s_cselect_b32 s84, 0, s84
    s_add_u32 s85, s84, 4096
    s_cmp_eq_u32 s85, 28672
    s_cselect_b32 s85, 0, s85
    s_add_u32 s86, s85, 4096
    s_cmp_eq_u32 s86, 28672
    s_cselect_b32 s86, 0, s86
    s_lshr_b32 s76, s77, 1
    v_bfe_u32 v43, v1, 2, 2
    v_lshrrev_b32 v6, 5, v1
    v_lshl_add_u32 v43, v6, 2, v43
    v_lshlrev_b32 v43, 7, v43
    v_bfe_u32 v6, v1, 3, 1
    v_xor_b32 v6, s76, v6
    v_lshl_add_u32 v43, v6, 6, v43
    v_bfe_u32 v6, v1, 4, 1
    v_lshl_add_u32 v43, v6, 5, v43
    v_and_b32 v6, 3, v1
    v_lshl_add_u32 v43, v6, 3, v43
    s_mul_i32 s90, s77, 40960
    s_add_u32 s87, s90, 8704
    s_add_u32 s88, s90, 29184
    s_mov_b32 s92, s36
    s_mov_b32 s93, s37
    s_mov_b32 s94, 1835008
    s_mov_b32 s95, 0x20000
    s_waitcnt vmcnt(0)
    v_mov_b32_dpp v46, v62 wave_shr:1 row_mask:0xf bank_mask:0xf
    v_mov_b32_dpp v47, v63 wave_shr:1 row_mask:0xf bank_mask:0xf
    v_perm_b32 v64, v60, v62, s66
    v_perm_b32 v65, v56, v58, s66
    v_perm_b32 v66, v52, v54, s66
    v_perm_b32 v67, v48, v50, s66
    ds_write_b128 v4, v[64:67] offset:4576
    v_perm_b32 v68, v58, v60, s66
    v_perm_b32 v69, v54, v56, s66
    v_perm_b32 v70, v50, v52, s66
    v_perm_b32 v71, v46, v48, s66
    ds_write_b128 v4, v[68:71] offset:0
    v_perm_b32 v72, v60, v62, s67
    v_perm_b32 v73, v56, v58, s67
    v_perm_b32 v74, v52, v54, s67
    v_perm_b32 v75, v48, v50, s67
    ds_write_b128 v4, v[72:75] offset:45536
    v_perm_b32 v76, v58, v60, s67
    v_perm_b32 v77, v54, v56, s67
    v_perm_b32 v78, v50, v52, s67
    v_perm_b32 v79, v46, v48, s67
    ds_write_b128 v4, v[76:79] offset:40960
    v_perm_b32 v64, v61, v63, s66
    v_perm_b32 v65, v57, v59, s66
    v_perm_b32 v66, v53, v55, s66
    v_perm_b32 v67, v49, v51, s66
    ds_write_b128 v5, v[64:67] offset:4576
    v_perm_b32 v68, v59, v61, s66
    v_perm_b32 v69, v55, v57, s66
    v_perm_b32 v70, v51, v53, s66
    v_perm_b32 v71, v47, v49, s66
    ds_write_b128 v5, v[68:71] offset:0
    v_perm_b32 v72, v61, v63, s67
    v_perm_b32 v73, v57, v59, s67
    v_perm_b32 v74, v53, v55, s67
    v_perm_b32 v75, v49, v51, s67
    ds_write_b128 v5, v[72:75] offset:45536
    v_perm_b32 v76, v59, v61, s67
    v_perm_b32 v77, v55, v57, s67
    v_perm_b32 v78, v51, v53, s67
    v_perm_b32 v79, v47, v49, s67
    ds_write_b128 v5, v[76:79] offset:40960
    s_waitcnt lgkmcnt(0)
    s_barrier
    s_add_u32 m0, s87, 0
    s_lshl_b32 s91, s80, 4
    buffer_load_dwordx4 v44, s[92:95], s91 offen lds
    s_add_u32 m0, m0, 1024
    s_nop 0
    buffer_load_dwordx4 v45, s[92:95], s91 offen lds
    s_add_u32 m0, s87, 2048
    s_add_u32 s91, s91, 16384
    buffer_load_dwordx4 v44, s[92:95], s91 offen lds
    s_add_u32 m0, m0, 1024
    s_nop 0
    buffer_load_dwordx4 v45, s[92:95], s91 offen lds
    s_add_u32 m0, s87, 4096
    s_add_u32 s91, s91, 16384
    buffer_load_dwordx4 v44, s[92:95], s91 offen lds
    s_add_u32 m0, m0, 1024
    s_nop 0
    buffer_load_dwordx4 v45, s[92:95], s91 offen lds
    s_add_u32 m0, s87, 6144
    s_add_u32 s91, s91, 16384
    buffer_load_dwordx4 v44, s[92:95], s91 offen lds
    s_add_u32 m0, m0, 1024
    s_nop 0
    buffer_load_dwordx4 v45, s[92:95], s91 offen lds
    s_add_u32 m0, s87, 8192
    s_lshl_b32 s91, s81, 4
    buffer_load_dwordx4 v44, s[92:95], s91 offen lds
    s_add_u32 m0, m0, 1024
    s_nop 0
    buffer_load_dwordx4 v45, s[92:95], s91 offen lds
    s_add_u32 m0, s87, 10240
    s_add_u32 s91, s91, 16384
    buffer_load_dwordx4 v44, s[92:95], s91 offen lds
    s_add_u32 m0, m0, 1024
    s_nop 0
    buffer_load_dwordx4 v45, s[92:95], s91 offen lds
    s_add_u32 m0, s87, 12288
    s_add_u32 s91, s91, 16384
    buffer_load_dwordx4 v44, s[92:95], s91 offen lds
    s_add_u32 m0, m0, 1024
    s_nop 0
    buffer_load_dwordx4 v45, s[92:95], s91 offen lds
    s_add_u32 m0, s87, 14336
    s_add_u32 s91, s91, 16384
    buffer_load_dwordx4 v44, s[92:95], s91 offen lds
    s_add_u32 m0, m0, 1024
    s_nop 0
    buffer_load_dwordx4 v45, s[92:95], s91 offen lds
    s_add_u32 m0, s87, 16384
    s_lshl_b32 s91, s82, 4
    buffer_load_dwordx4 v44, s[92:95], s91 offen lds
    s_add_u32 m0, m0, 1024
    s_nop 0
    buffer_load_dwordx4 v45, s[92:95], s91 offen lds
    s_add_u32 m0, s87, 18432
    s_add_u32 s91, s91, 16384
    buffer_load_dwordx4 v44, s[92:95], s91 offen lds
    s_add_u32 m0, m0, 1024
    s_nop 0
    buffer_load_dwordx4 v45, s[92:95], s91 offen lds
    s_lshl_b32 s72, s14, 16
    s_and_b32 s73, s14, 0xffff0000
    s_lshl_b32 s74, s15, 16
    s_and_b32 s75, s15, 0xffff0000
    v_lshlrev_b32 v64, 16, v48
    v_and_b32 v65, 0xffff0000, v48
    v_lshlrev_b32 v66, 16, v49
    v_and_b32 v67, 0xffff0000, v49
    v_lshlrev_b32 v68, 16, v50
    v_and_b32 v69, 0xffff0000, v50
    v_lshlrev_b32 v70, 16, v51
    v_and_b32 v71, 0xffff0000, v51
    v_lshlrev_b32 v72, 16, v52
    v_and_b32 v73, 0xffff0000, v52
    v_lshlrev_b32 v74, 16, v53
    v_and_b32 v75, 0xffff0000, v53
    v_lshlrev_b32 v76, 16, v54
    v_and_b32 v77, 0xffff0000, v54
    v_lshlrev_b32 v78, 16, v55
    v_and_b32 v79, 0xffff0000, v55
    v_lshlrev_b32 v80, 16, v56
    v_and_b32 v81, 0xffff0000, v56
    v_lshlrev_b32 v82, 16, v57
    v_and_b32 v83, 0xffff0000, v57
    v_lshlrev_b32 v84, 16, v58
    v_and_b32 v85, 0xffff0000, v58
    v_lshlrev_b32 v86, 16, v59
    v_and_b32 v87, 0xffff0000, v59
    v_lshlrev_b32 v88, 16, v60
    v_and_b32 v89, 0xffff0000, v60
    v_lshlrev_b32 v90, 16, v61
    v_and_b32 v91, 0xffff0000, v61
    v_lshlrev_b32 v92, 16, v62
    v_and_b32 v93, 0xffff0000, v62
    v_lshlrev_b32 v94, 16, v63
    v_and_b32 v95, 0xffff0000, v63
    v_lshrrev_b32 v4, 5, v8
    v_mul_u32_u24 v4, 1088, v4
    v_and_b32 v5, 3, v8
    v_mul_u32_u24 v5, 272, v5
    v_bfe_u32 v6, v8, 2, 3
    v_lshl_add_u32 v4, v6, 5, v4
    v_add_u32 v4, v4, v5
    v_add_u32 v5, 81920, v4
    v_lshlrev_b32 v6, 4, v8
    s_lshl_b32 s68, s6, 14
    s_add_u32 s68, s68, 9175040
    s_add_u32 s69, s68, 4096
    s_add_u32 s70, s68, 8192
    s_add_u32 s71, s68, 12288
    s_lshl_b32 s64, s7, 9
    s_lshl_b32 s65, s6, 2
    s_add_u32 s64, s64, s65
    s_lshl_b32 s64, s64, 5
    s_add_u32 s64, s64, 11354112
    s_waitcnt vmcnt(0)
    v_add_u32 v240, s87, v43
    v_xor_b32 v241, 64, v240
    ds_read_b64_tr_b16 v[128:129], v240 offset:0
    ds_read_b64_tr_b16 v[130:131], v240 offset:1024
    ds_read_b64_tr_b16 v[132:133], v241 offset:0
    ds_read_b64_tr_b16 v[134:135], v241 offset:1024
    ds_read_b64_tr_b16 v[136:137], v240 offset:2048
    ds_read_b64_tr_b16 v[138:139], v240 offset:3072
    ds_read_b64_tr_b16 v[140:141], v241 offset:2048
    ds_read_b64_tr_b16 v[142:143], v241 offset:3072
    ds_read_b64_tr_b16 v[144:145], v240 offset:4096
    ds_read_b64_tr_b16 v[146:147], v240 offset:5120
    ds_read_b64_tr_b16 v[148:149], v241 offset:4096
    ds_read_b64_tr_b16 v[150:151], v241 offset:5120
    ds_read_b64_tr_b16 v[152:153], v240 offset:6144
    ds_read_b64_tr_b16 v[154:155], v240 offset:7168
    ds_read_b64_tr_b16 v[156:157], v241 offset:6144
    ds_read_b64_tr_b16 v[158:159], v241 offset:7168
    ds_read_b64_tr_b16 v[160:161], v240 offset:8192
    ds_read_b64_tr_b16 v[162:163], v240 offset:9216
    ds_read_b64_tr_b16 v[164:165], v241 offset:8192
    ds_read_b64_tr_b16 v[166:167], v241 offset:9216
    ds_read_b64_tr_b16 v[168:169], v240 offset:10240
    ds_read_b64_tr_b16 v[170:171], v240 offset:11264
    ds_read_b64_tr_b16 v[172:173], v241 offset:10240
    ds_read_b64_tr_b16 v[174:175], v241 offset:11264
    ds_read_b64_tr_b16 v[176:177], v240 offset:12288
    ds_read_b64_tr_b16 v[178:179], v240 offset:13312
    ds_read_b64_tr_b16 v[180:181], v241 offset:12288
    ds_read_b64_tr_b16 v[182:183], v241 offset:13312
    ds_read_b64_tr_b16 v[184:185], v240 offset:14336
    ds_read_b64_tr_b16 v[186:187], v240 offset:15360
    ds_read_b64_tr_b16 v[188:189], v241 offset:14336
    ds_read_b64_tr_b16 v[190:191], v241 offset:15360
    ds_read_b64_tr_b16 v[192:193], v240 offset:16384
    ds_read_b64_tr_b16 v[194:195], v240 offset:17408
    ds_read_b64_tr_b16 v[196:197], v241 offset:16384
    ds_read_b64_tr_b16 v[198:199], v241 offset:17408
    ds_read_b64_tr_b16 v[200:201], v240 offset:18432
    ds_read_b64_tr_b16 v[202:203], v240 offset:19456
    ds_read_b64_tr_b16 v[204:205], v241 offset:18432
    ds_read_b64_tr_b16 v[206:207], v241 offset:19456
    s_waitcnt lgkmcnt(0)
    s_add_u32 m0, s87, 12288
    s_lshl_b32 s91, s82, 4
    s_add_u32 s91, s91, 32768
    buffer_load_dwordx4 v44, s[92:95], s91 offen lds
    s_add_u32 m0, m0, 1024
    s_nop 0
    buffer_load_dwordx4 v45, s[92:95], s91 offen lds
    s_add_u32 m0, s87, 14336
    s_add_u32 s91, s91, 16384
    buffer_load_dwordx4 v44, s[92:95], s91 offen lds
    s_add_u32 m0, m0, 1024
    s_nop 0
    buffer_load_dwordx4 v45, s[92:95], s91 offen lds
    s_add_u32 m0, s87, 16384
    s_lshl_b32 s91, s83, 4
    buffer_load_dwordx4 v44, s[92:95], s91 offen lds
    s_add_u32 m0, m0, 1024
    s_nop 0
    buffer_load_dwordx4 v45, s[92:95], s91 offen lds
    s_add_u32 m0, s87, 18432
    s_add_u32 s91, s91, 16384
    buffer_load_dwordx4 v44, s[92:95], s91 offen lds
    s_add_u32 m0, m0, 1024
    s_nop 0
    buffer_load_dwordx4 v45, s[92:95], s91 offen lds
    s_add_u32 m0, s87, 0
    s_lshl_b32 s91, s83, 4
    s_add_u32 s91, s91, 32768
    buffer_load_dwordx4 v44, s[92:95], s91 offen lds
    s_add_u32 m0, m0, 1024
    s_nop 0
    buffer_load_dwordx4 v45, s[92:95], s91 offen lds
    s_add_u32 m0, s87, 2048
    s_add_u32 s91, s91, 16384
    buffer_load_dwordx4 v44, s[92:95], s91 offen lds
    s_add_u32 m0, m0, 1024
    s_nop 0
    buffer_load_dwordx4 v45, s[92:95], s91 offen lds
    s_add_u32 m0, s87, 4096
    s_lshl_b32 s91, s84, 4
    buffer_load_dwordx4 v44, s[92:95], s91 offen lds
    s_add_u32 m0, m0, 1024
    s_nop 0
    buffer_load_dwordx4 v45, s[92:95], s91 offen lds
    s_add_u32 m0, s87, 6144
    s_add_u32 s91, s91, 16384
    buffer_load_dwordx4 v44, s[92:95], s91 offen lds
    s_add_u32 m0, m0, 1024
    s_nop 0
    buffer_load_dwordx4 v45, s[92:95], s91 offen lds
    s_add_u32 m0, s87, 8192
    s_add_u32 s91, s91, 16384
    buffer_load_dwordx4 v44, s[92:95], s91 offen lds
    s_add_u32 m0, m0, 1024
    s_nop 0
    buffer_load_dwordx4 v45, s[92:95], s91 offen lds
    s_add_u32 m0, s87, 10240
    s_add_u32 s91, s91, 16384
    buffer_load_dwordx4 v44, s[92:95], s91 offen lds
    s_add_u32 m0, m0, 1024
    s_nop 0
    buffer_load_dwordx4 v45, s[92:95], s91 offen lds
    s_barrier
    v_mov_b32 v7, 0
    global_load_dword v7, v7, s[44:45]
    ds_read_b128 v[96:99], v4 offset:0
    ds_read_b128 v[100:103], v4 offset:16
    ds_read_b128 v[104:107], v4 offset:40960
    ds_read_b128 v[108:111], v4 offset:40976
    ds_read_b128 v[112:115], v5 offset:0
    ds_read_b128 v[116:119], v5 offset:16
    ds_read_b128 v[120:123], v5 offset:40960
    ds_read_b128 v[124:127], v5 offset:40976
    s_waitcnt lgkmcnt(6)
    v_fma_f32 v64, v64, s72, v96
    v_fma_f32 v68, v68, s72, v100
    v_fma_f32 v72, v72, s72, v97
    v_fma_f32 v76, v76, s72, v101
    v_fma_f32 v80, v80, s72, v98
    v_fma_f32 v84, v84, s72, v102
    v_fma_f32 v88, v88, s72, v99
    v_fma_f32 v92, v92, s72, v103
    s_waitcnt lgkmcnt(4)
    v_fma_f32 v65, v65, s73, v104
    v_fma_f32 v69, v69, s73, v108
    v_fma_f32 v73, v73, s73, v105
    v_fma_f32 v77, v77, s73, v109
    v_fma_f32 v81, v81, s73, v106
    v_fma_f32 v85, v85, s73, v110
    v_fma_f32 v89, v89, s73, v107
    v_fma_f32 v93, v93, s73, v111
    s_waitcnt lgkmcnt(2)
    v_fma_f32 v66, v66, s74, v112
    v_fma_f32 v70, v70, s74, v116
    v_fma_f32 v74, v74, s74, v113
    v_fma_f32 v78, v78, s74, v117
    v_fma_f32 v82, v82, s74, v114
    v_fma_f32 v86, v86, s74, v118
    v_fma_f32 v90, v90, s74, v115
    v_fma_f32 v94, v94, s74, v119
    s_waitcnt lgkmcnt(0)
    v_fma_f32 v67, v67, s75, v120
    v_fma_f32 v71, v71, s75, v124
    v_fma_f32 v75, v75, s75, v121
    v_fma_f32 v79, v79, s75, v125
    v_fma_f32 v83, v83, s75, v122
    v_fma_f32 v87, v87, s75, v126
    v_fma_f32 v91, v91, s75, v123
    v_fma_f32 v95, v95, s75, v127
    v_cvt_pk_bf16_f32 v16, v64, v65
    v_cvt_pk_bf16_f32 v17, v66, v67
    v_cvt_pk_bf16_f32 v18, v68, v69
    v_cvt_pk_bf16_f32 v19, v70, v71
    v_cvt_pk_bf16_f32 v20, v72, v73
    v_cvt_pk_bf16_f32 v21, v74, v75
    v_cvt_pk_bf16_f32 v22, v76, v77
    v_cvt_pk_bf16_f32 v23, v78, v79
    v_cvt_pk_bf16_f32 v24, v80, v81
    v_cvt_pk_bf16_f32 v25, v82, v83
    v_cvt_pk_bf16_f32 v26, v84, v85
    v_cvt_pk_bf16_f32 v27, v86, v87
    v_cvt_pk_bf16_f32 v28, v88, v89
    v_cvt_pk_bf16_f32 v29, v90, v91
    v_cvt_pk_bf16_f32 v30, v92, v93
    v_cvt_pk_bf16_f32 v31, v94, v95
    buffer_store_dwordx4 v[16:19], v6, s[52:55], s68 offen sc1
    buffer_store_dwordx4 v[20:23], v6, s[52:55], s69 offen sc1
    buffer_store_dwordx4 v[24:27], v6, s[52:55], s70 offen sc1
    buffer_store_dwordx4 v[28:31], v6, s[52:55], s71 offen sc1
    s_waitcnt vmcnt(0)
    v_readfirstlane_b32 s79, v7
    s_ff1_i32_b32 s79, s79
    s_cmp_ge_i32 s79, 4
    s_cbranch_scc1 Ltag3
    s_mov_b32 s76, 40000
    v_mov_b32 v4, 0
Ltag3p:
    global_load_dword v7, v4, s[44:45] sc1
    s_sub_u32 s76, s76, 1
    s_waitcnt vmcnt(0)
    v_readfirstlane_b32 s79, v7
    s_ff1_i32_b32 s79, s79
    s_cmp_ge_i32 s79, 4
    s_cbranch_scc1 Ltag3
    s_sleep 12
    s_cmp_lg_u32 s76, 0
    s_cbranch_scc1 Ltag3p
Ltag3:
    s_mov_b32 s79, 16
    v_mov_b32 v4, s79
    v_mov_b32 v5, s64
    s_mov_b64 exec, 1
    global_store_dword v5, v4, s[46:47] sc1
    s_mov_b64 exec, -1
    v_add_u32 v240, s87, v43
    v_xor_b32 v241, 64, v240
    ds_read_b64_tr_b16 v[208:209], v240 offset:12288
    ds_read_b64_tr_b16 v[210:211], v240 offset:13312
    ds_read_b64_tr_b16 v[212:213], v241 offset:12288
    ds_read_b64_tr_b16 v[214:215], v241 offset:13312
    ds_read_b64_tr_b16 v[216:217], v240 offset:14336
    ds_read_b64_tr_b16 v[218:219], v240 offset:15360
    ds_read_b64_tr_b16 v[220:221], v241 offset:14336
    ds_read_b64_tr_b16 v[222:223], v241 offset:15360
    ds_read_b64_tr_b16 v[224:225], v240 offset:16384
    ds_read_b64_tr_b16 v[226:227], v240 offset:17408
    ds_read_b64_tr_b16 v[228:229], v241 offset:16384
    ds_read_b64_tr_b16 v[230:231], v241 offset:17408
    ds_read_b64_tr_b16 v[232:233], v240 offset:18432
    ds_read_b64_tr_b16 v[234:235], v240 offset:19456
    ds_read_b64_tr_b16 v[236:237], v241 offset:18432
    ds_read_b64_tr_b16 v[238:239], v241 offset:19456
    s_add_u32 m0, s87, 20480
    s_lshl_b32 s91, s86, 4
    buffer_load_dwordx4 v44, s[92:95], s91 offen lds
    s_add_u32 m0, m0, 1024
    s_nop 0
    buffer_load_dwordx4 v45, s[92:95], s91 offen lds
    s_add_u32 m0, s87, 22528
    s_add_u32 s91, s91, 16384
    buffer_load_dwordx4 v44, s[92:95], s91 offen lds
    s_add_u32 m0, m0, 1024
    s_nop 0
    buffer_load_dwordx4 v45, s[92:95], s91 offen lds
    s_add_u32 m0, s87, 24576
    s_add_u32 s91, s91, 16384
    buffer_load_dwordx4 v44, s[92:95], s91 offen lds
    s_add_u32 m0, m0, 1024
    s_nop 0
    buffer_load_dwordx4 v45, s[92:95], s91 offen lds
    s_add_u32 m0, s87, 26624
    s_add_u32 s91, s91, 16384
    buffer_load_dwordx4 v44, s[92:95], s91 offen lds
    s_add_u32 m0, m0, 1024
    s_nop 0
    buffer_load_dwordx4 v45, s[92:95], s91 offen lds
    s_waitcnt lgkmcnt(0)
    s_add_u32 m0, s87, 12288
    s_lshl_b32 s91, s85, 4
    buffer_load_dwordx4 v44, s[92:95], s91 offen lds
    s_add_u32 m0, m0, 1024
    s_nop 0
    buffer_load_dwordx4 v45, s[92:95], s91 offen lds
    s_add_u32 m0, s87, 14336
    s_add_u32 s91, s91, 16384
    buffer_load_dwordx4 v44, s[92:95], s91 offen lds
    s_add_u32 m0, m0, 1024
    s_nop 0
    buffer_load_dwordx4 v45, s[92:95], s91 offen lds
    s_add_u32 m0, s87, 16384
    s_add_u32 s91, s91, 16384
    buffer_load_dwordx4 v44, s[92:95], s91 offen lds
    s_add_u32 m0, m0, 1024
    s_nop 0
    buffer_load_dwordx4 v45, s[92:95], s91 offen lds
    s_add_u32 m0, s87, 18432
    s_add_u32 s91, s91, 16384
    buffer_load_dwordx4 v44, s[92:95], s91 offen lds
    s_add_u32 m0, m0, 1024
    s_nop 0
    buffer_load_dwordx4 v45, s[92:95], s91 offen lds
    s_branch Lp2_main
La_idle:
    s_cmp_lt_u32 s3, 4
    s_cbranch_scc0 Li_hi
    s_mul_i32 s90, s3, 40960
    s_waitcnt lgkmcnt(0)
    v_mov_b32 v4, s3
    s_mov_b32 s52, s46
    s_mov_b32 s53, s47
    s_mov_b32 s54, 11427840
    s_mov_b32 s55, 0x20000
    s_mov_b32 s48, s16
    s_mov_b32 s49, s17
    s_mov_b32 s50, 2097152
    s_mov_b32 s51, 0x20000
    s_lshl_b32 s68, s4, 1
    s_add_u32 s68, s68, s5
    s_sub_u32 s68, s68, 30
    s_lshl_b32 s68, s68, 2
    s_add_u32 s68, s68, s3
    s_lshl_b32 s64, s68, 7
    s_add_u32 s64, s64, 11419648
    s_lshl_b32 s68, s68, 5
Li_gate:
    s_lshl_b32 s69, s68, 10
    s_add_u32 s71, s69, 4096
    v_lshlrev_b32 v4, 4, v1
    global_load_dwordx4 v[96:99], v4, s[40:41]
    buffer_load_dwordx4 v[64:67], v4, s[48:51], s69 offen offset:0
    buffer_load_dwordx4 v[68:71], v4, s[48:51], s69 offen offset:1024
    buffer_load_dwordx4 v[72:75], v4, s[48:51], s69 offen offset:2048
    buffer_load_dwordx4 v[76:79], v4, s[48:51], s69 offen offset:3072
    buffer_load_dwordx4 v[80:83], v4, s[48:51], s71 offen offset:0
    buffer_load_dwordx4 v[84:87], v4, s[48:51], s71 offen offset:1024
    buffer_load_dwordx4 v[88:91], v4, s[48:51], s71 offen offset:2048
    buffer_load_dwordx4 v[92:95], v4, s[48:51], s71 offen offset:3072
    s_waitcnt vmcnt(8)
    v_lshlrev_b32 v100, 16, v96
    v_and_b32 v101, 0xffff0000, v96
    v_lshlrev_b32 v102, 16, v97
    v_and_b32 v103, 0xffff0000, v97
    v_lshlrev_b32 v104, 16, v98
    v_and_b32 v105, 0xffff0000, v98
    v_lshlrev_b32 v106, 16, v99
    v_and_b32 v107, 0xffff0000, v99
    s_waitcnt vmcnt(7)
    v_lshlrev_b32 v110, 16, v64
    v_and_b32 v111, 0xffff0000, v64
    v_lshlrev_b32 v112, 16, v65
    v_and_b32 v113, 0xffff0000, v65
    v_lshlrev_b32 v114, 16, v66
    v_and_b32 v115, 0xffff0000, v66
    v_lshlrev_b32 v116, 16, v67
    v_and_b32 v117, 0xffff0000, v67
    v_mul_f32 v110, v110, v100
    v_mul_f32 v111, v111, v101
    v_mul_f32 v112, v112, v102
    v_mul_f32 v113, v113, v103
    v_mul_f32 v114, v114, v104
    v_mul_f32 v115, v115, v105
    v_mul_f32 v116, v116, v106
    v_mul_f32 v117, v117, v107
    v_cvt_pk_bf16_f32 v120, v110, v111
    v_cvt_pk_bf16_f32 v121, v112, v113
    v_cvt_pk_bf16_f32 v122, v114, v115
    v_cvt_pk_bf16_f32 v123, v116, v117
    v_lshlrev_b32 v110, 16, v120
    v_and_b32 v111, 0xffff0000, v120
    v_lshlrev_b32 v112, 16, v121
    v_and_b32 v113, 0xffff0000, v121
    v_lshlrev_b32 v114, 16, v122
    v_and_b32 v115, 0xffff0000, v122
    v_lshlrev_b32 v116, 16, v123
    v_and_b32 v117, 0xffff0000, v123
    v_add_f32 v110, v110, v114
    v_add_f32 v111, v111, v115
    v_add_f32 v112, v112, v116
    v_add_f32 v113, v113, v117
    v_add_f32 v110, v110, v112
    v_add_f32 v111, v111, v113
    v_add_f32 v24, v110, v111
    s_waitcnt vmcnt(6)
    v_lshlrev_b32 v110, 16, v68
    v_and_b32 v111, 0xffff0000, v68
    v_lshlrev_b32 v112, 16, v69
    v_and_b32 v113, 0xffff0000, v69
    v_lshlrev_b32 v114, 16, v70
    v_and_b32 v115, 0xffff0000, v70
    v_lshlrev_b32 v116, 16, v71
    v_and_b32 v117, 0xffff0000, v71
    v_mul_f32 v110, v110, v100
    v_mul_f32 v111, v111, v101
    v_mul_f32 v112, v112, v102
    v_mul_f32 v113, v113, v103
    v_mul_f32 v114, v114, v104
    v_mul_f32 v115, v115, v105
    v_mul_f32 v116, v116, v106
    v_mul_f32 v117, v117, v107
    v_cvt_pk_bf16_f32 v120, v110, v111
    v_cvt_pk_bf16_f32 v121, v112, v113
    v_cvt_pk_bf16_f32 v122, v114, v115
    v_cvt_pk_bf16_f32 v123, v116, v117
    v_lshlrev_b32 v110, 16, v120
    v_and_b32 v111, 0xffff0000, v120
    v_lshlrev_b32 v112, 16, v121
    v_and_b32 v113, 0xffff0000, v121
    v_lshlrev_b32 v114, 16, v122
    v_and_b32 v115, 0xffff0000, v122
    v_lshlrev_b32 v116, 16, v123
    v_and_b32 v117, 0xffff0000, v123
    v_add_f32 v110, v110, v114
    v_add_f32 v111, v111, v115
    v_add_f32 v112, v112, v116
    v_add_f32 v113, v113, v117
    v_add_f32 v110, v110, v112
    v_add_f32 v111, v111, v113
    v_add_f32 v25, v110, v111
    s_waitcnt vmcnt(5)
    v_lshlrev_b32 v110, 16, v72
    v_and_b32 v111, 0xffff0000, v72
    v_lshlrev_b32 v112, 16, v73
    v_and_b32 v113, 0xffff0000, v73
    v_lshlrev_b32 v114, 16, v74
    v_and_b32 v115, 0xffff0000, v74
    v_lshlrev_b32 v116, 16, v75
    v_and_b32 v117, 0xffff0000, v75
    v_mul_f32 v110, v110, v100
    v_mul_f32 v111, v111, v101
    v_mul_f32 v112, v112, v102
    v_mul_f32 v113, v113, v103
    v_mul_f32 v114, v114, v104
    v_mul_f32 v115, v115, v105
    v_mul_f32 v116, v116, v106
    v_mul_f32 v117, v117, v107
    v_cvt_pk_bf16_f32 v120, v110, v111
    v_cvt_pk_bf16_f32 v121, v112, v113
    v_cvt_pk_bf16_f32 v122, v114, v115
    v_cvt_pk_bf16_f32 v123, v116, v117
    v_lshlrev_b32 v110, 16, v120
    v_and_b32 v111, 0xffff0000, v120
    v_lshlrev_b32 v112, 16, v121
    v_and_b32 v113, 0xffff0000, v121
    v_lshlrev_b32 v114, 16, v122
    v_and_b32 v115, 0xffff0000, v122
    v_lshlrev_b32 v116, 16, v123
    v_and_b32 v117, 0xffff0000, v123
    v_add_f32 v110, v110, v114
    v_add_f32 v111, v111, v115
    v_add_f32 v112, v112, v116
    v_add_f32 v113, v113, v117
    v_add_f32 v110, v110, v112
    v_add_f32 v111, v111, v113
    v_add_f32 v26, v110, v111
    s_waitcnt vmcnt(4)
    v_lshlrev_b32 v110, 16, v76
    v_and_b32 v111, 0xffff0000, v76
    v_lshlrev_b32 v112, 16, v77
    v_and_b32 v113, 0xffff0000, v77
    v_lshlrev_b32 v114, 16, v78
    v_and_b32 v115, 0xffff0000, v78
    v_lshlrev_b32 v116, 16, v79
    v_and_b32 v117, 0xffff0000, v79
    v_mul_f32 v110, v110, v100
    v_mul_f32 v111, v111, v101
    v_mul_f32 v112, v112, v102
    v_mul_f32 v113, v113, v103
    v_mul_f32 v114, v114, v104
    v_mul_f32 v115, v115, v105
    v_mul_f32 v116, v116, v106
    v_mul_f32 v117, v117, v107
    v_cvt_pk_bf16_f32 v120, v110, v111
    v_cvt_pk_bf16_f32 v121, v112, v113
    v_cvt_pk_bf16_f32 v122, v114, v115
    v_cvt_pk_bf16_f32 v123, v116, v117
    v_lshlrev_b32 v110, 16, v120
    v_and_b32 v111, 0xffff0000, v120
    v_lshlrev_b32 v112, 16, v121
    v_and_b32 v113, 0xffff0000, v121
    v_lshlrev_b32 v114, 16, v122
    v_and_b32 v115, 0xffff0000, v122
    v_lshlrev_b32 v116, 16, v123
    v_and_b32 v117, 0xffff0000, v123
    v_add_f32 v110, v110, v114
    v_add_f32 v111, v111, v115
    v_add_f32 v112, v112, v116
    v_add_f32 v113, v113, v117
    v_add_f32 v110, v110, v112
    v_add_f32 v111, v111, v113
    v_add_f32 v27, v110, v111
    s_waitcnt vmcnt(3)
    v_lshlrev_b32 v110, 16, v80
    v_and_b32 v111, 0xffff0000, v80
    v_lshlrev_b32 v112, 16, v81
    v_and_b32 v113, 0xffff0000, v81
    v_lshlrev_b32 v114, 16, v82
    v_and_b32 v115, 0xffff0000, v82
    v_lshlrev_b32 v116, 16, v83
    v_and_b32 v117, 0xffff0000, v83
    v_mul_f32 v110, v110, v100
    v_mul_f32 v111, v111, v101
    v_mul_f32 v112, v112, v102
    v_mul_f32 v113, v113, v103
    v_mul_f32 v114, v114, v104
    v_mul_f32 v115, v115, v105
    v_mul_f32 v116, v116, v106
    v_mul_f32 v117, v117, v107
    v_cvt_pk_bf16_f32 v120, v110, v111
    v_cvt_pk_bf16_f32 v121, v112, v113
    v_cvt_pk_bf16_f32 v122, v114, v115
    v_cvt_pk_bf16_f32 v123, v116, v117
    v_lshlrev_b32 v110, 16, v120
    v_and_b32 v111, 0xffff0000, v120
    v_lshlrev_b32 v112, 16, v121
    v_and_b32 v113, 0xffff0000, v121
    v_lshlrev_b32 v114, 16, v122
    v_and_b32 v115, 0xffff0000, v122
    v_lshlrev_b32 v116, 16, v123
    v_and_b32 v117, 0xffff0000, v123
    v_add_f32 v110, v110, v114
    v_add_f32 v111, v111, v115
    v_add_f32 v112, v112, v116
    v_add_f32 v113, v113, v117
    v_add_f32 v110, v110, v112
    v_add_f32 v111, v111, v113
    v_add_f32 v28, v110, v111
    s_waitcnt vmcnt(2)
    v_lshlrev_b32 v110, 16, v84
    v_and_b32 v111, 0xffff0000, v84
    v_lshlrev_b32 v112, 16, v85
    v_and_b32 v113, 0xffff0000, v85
    v_lshlrev_b32 v114, 16, v86
    v_and_b32 v115, 0xffff0000, v86
    v_lshlrev_b32 v116, 16, v87
    v_and_b32 v117, 0xffff0000, v87
    v_mul_f32 v110, v110, v100
    v_mul_f32 v111, v111, v101
    v_mul_f32 v112, v112, v102
    v_mul_f32 v113, v113, v103
    v_mul_f32 v114, v114, v104
    v_mul_f32 v115, v115, v105
    v_mul_f32 v116, v116, v106
    v_mul_f32 v117, v117, v107
    v_cvt_pk_bf16_f32 v120, v110, v111
    v_cvt_pk_bf16_f32 v121, v112, v113
    v_cvt_pk_bf16_f32 v122, v114, v115
    v_cvt_pk_bf16_f32 v123, v116, v117
    v_lshlrev_b32 v110, 16, v120
    v_and_b32 v111, 0xffff0000, v120
    v_lshlrev_b32 v112, 16, v121
    v_and_b32 v113, 0xffff0000, v121
    v_lshlrev_b32 v114, 16, v122
    v_and_b32 v115, 0xffff0000, v122
    v_lshlrev_b32 v116, 16, v123
    v_and_b32 v117, 0xffff0000, v123
    v_add_f32 v110, v110, v114
    v_add_f32 v111, v111, v115
    v_add_f32 v112, v112, v116
    v_add_f32 v113, v113, v117
    v_add_f32 v110, v110, v112
    v_add_f32 v111, v111, v113
    v_add_f32 v29, v110, v111
    s_waitcnt vmcnt(1)
    v_lshlrev_b32 v110, 16, v88
    v_and_b32 v111, 0xffff0000, v88
    v_lshlrev_b32 v112, 16, v89
    v_and_b32 v113, 0xffff0000, v89
    v_lshlrev_b32 v114, 16, v90
    v_and_b32 v115, 0xffff0000, v90
    v_lshlrev_b32 v116, 16, v91
    v_and_b32 v117, 0xffff0000, v91
    v_mul_f32 v110, v110, v100
    v_mul_f32 v111, v111, v101
    v_mul_f32 v112, v112, v102
    v_mul_f32 v113, v113, v103
    v_mul_f32 v114, v114, v104
    v_mul_f32 v115, v115, v105
    v_mul_f32 v116, v116, v106
    v_mul_f32 v117, v117, v107
    v_cvt_pk_bf16_f32 v120, v110, v111
    v_cvt_pk_bf16_f32 v121, v112, v113
    v_cvt_pk_bf16_f32 v122, v114, v115
    v_cvt_pk_bf16_f32 v123, v116, v117
    v_lshlrev_b32 v110, 16, v120
    v_and_b32 v111, 0xffff0000, v120
    v_lshlrev_b32 v112, 16, v121
    v_and_b32 v113, 0xffff0000, v121
    v_lshlrev_b32 v114, 16, v122
    v_and_b32 v115, 0xffff0000, v122
    v_lshlrev_b32 v116, 16, v123
    v_and_b32 v117, 0xffff0000, v123
    v_add_f32 v110, v110, v114
    v_add_f32 v111, v111, v115
    v_add_f32 v112, v112, v116
    v_add_f32 v113, v113, v117
    v_add_f32 v110, v110, v112
    v_add_f32 v111, v111, v113
    v_add_f32 v30, v110, v111
    s_waitcnt vmcnt(0)
    v_lshlrev_b32 v110, 16, v92
    v_and_b32 v111, 0xffff0000, v92
    v_lshlrev_b32 v112, 16, v93
    v_and_b32 v113, 0xffff0000, v93
    v_lshlrev_b32 v114, 16, v94
    v_and_b32 v115, 0xffff0000, v94
    v_lshlrev_b32 v116, 16, v95
    v_and_b32 v117, 0xffff0000, v95
    v_mul_f32 v110, v110, v100
    v_mul_f32 v111, v111, v101
    v_mul_f32 v112, v112, v102
    v_mul_f32 v113, v113, v103
    v_mul_f32 v114, v114, v104
    v_mul_f32 v115, v115, v105
    v_mul_f32 v116, v116, v106
    v_mul_f32 v117, v117, v107
    v_cvt_pk_bf16_f32 v120, v110, v111
    v_cvt_pk_bf16_f32 v121, v112, v113
    v_cvt_pk_bf16_f32 v122, v114, v115
    v_cvt_pk_bf16_f32 v123, v116, v117
    v_lshlrev_b32 v110, 16, v120
    v_and_b32 v111, 0xffff0000, v120
    v_lshlrev_b32 v112, 16, v121
    v_and_b32 v113, 0xffff0000, v121
    v_lshlrev_b32 v114, 16, v122
    v_and_b32 v115, 0xffff0000, v122
    v_lshlrev_b32 v116, 16, v123
    v_and_b32 v117, 0xffff0000, v123
    v_add_f32 v110, v110, v114
    v_add_f32 v111, v111, v115
    v_add_f32 v112, v112, v116
    v_add_f32 v113, v113, v117
    v_add_f32 v110, v110, v112
    v_add_f32 v111, v111, v113
    v_add_f32 v31, v110, v111
    s_nop 1
    v_add_f32_dpp v24, v24, v24 quad_perm:[1,0,3,2] row_mask:0xf bank_mask:0xf
    v_add_f32_dpp v25, v25, v25 quad_perm:[1,0,3,2] row_mask:0xf bank_mask:0xf
    v_add_f32_dpp v26, v26, v26 quad_perm:[1,0,3,2] row_mask:0xf bank_mask:0xf
    v_add_f32_dpp v27, v27, v27 quad_perm:[1,0,3,2] row_mask:0xf bank_mask:0xf
    v_add_f32_dpp v28, v28, v28 quad_perm:[1,0,3,2] row_mask:0xf bank_mask:0xf
    v_add_f32_dpp v29, v29, v29 quad_perm:[1,0,3,2] row_mask:0xf bank_mask:0xf
    v_add_f32_dpp v30, v30, v30 quad_perm:[1,0,3,2] row_mask:0xf bank_mask:0xf
    v_add_f32_dpp v31, v31, v31 quad_perm:[1,0,3,2] row_mask:0xf bank_mask:0xf
    s_nop 1
    v_add_f32_dpp v24, v24, v24 quad_perm:[2,3,0,1] row_mask:0xf bank_mask:0xf
    v_add_f32_dpp v25, v25, v25 quad_perm:[2,3,0,1] row_mask:0xf bank_mask:0xf
    v_add_f32_dpp v26, v26, v26 quad_perm:[2,3,0,1] row_mask:0xf bank_mask:0xf
    v_add_f32_dpp v27, v27, v27 quad_perm:[2,3,0,1] row_mask:0xf bank_mask:0xf
    v_add_f32_dpp v28, v28, v28 quad_perm:[2,3,0,1] row_mask:0xf bank_mask:0xf
    v_add_f32_dpp v29, v29, v29 quad_perm:[2,3,0,1] row_mask:0xf bank_mask:0xf
    v_add_f32_dpp v30, v30, v30 quad_perm:[2,3,0,1] row_mask:0xf bank_mask:0xf
    v_add_f32_dpp v31, v31, v31 quad_perm:[2,3,0,1] row_mask:0xf bank_mask:0xf
    s_nop 1
    v_add_f32_dpp v24, v24, v24 row_half_mirror row_mask:0xf bank_mask:0xf
    v_add_f32_dpp v25, v25, v25 row_half_mirror row_mask:0xf bank_mask:0xf
    v_add_f32_dpp v26, v26, v26 row_half_mirror row_mask:0xf bank_mask:0xf
    v_add_f32_dpp v27, v27, v27 row_half_mirror row_mask:0xf bank_mask:0xf
    v_add_f32_dpp v28, v28, v28 row_half_mirror row_mask:0xf bank_mask:0xf
    v_add_f32_dpp v29, v29, v29 row_half_mirror row_mask:0xf bank_mask:0xf
    v_add_f32_dpp v30, v30, v30 row_half_mirror row_mask:0xf bank_mask:0xf
    v_add_f32_dpp v31, v31, v31 row_half_mirror row_mask:0xf bank_mask:0xf
    s_nop 1
    v_add_f32_dpp v24, v24, v24 row_mirror row_mask:0xf bank_mask:0xf
    v_add_f32_dpp v25, v25, v25 row_mirror row_mask:0xf bank_mask:0xf
    v_add_f32_dpp v26, v26, v26 row_mirror row_mask:0xf bank_mask:0xf
    v_add_f32_dpp v27, v27, v27 row_mirror row_mask:0xf bank_mask:0xf
    v_add_f32_dpp v28, v28, v28 row_mirror row_mask:0xf bank_mask:0xf
    v_add_f32_dpp v29, v29, v29 row_mirror row_mask:0xf bank_mask:0xf
    v_add_f32_dpp v30, v30, v30 row_mirror row_mask:0xf bank_mask:0xf
    v_add_f32_dpp v31, v31, v31 row_mirror row_mask:0xf bank_mask:0xf
    s_nop 1
    v_add_f32_dpp v24, v24, v24 row_bcast:15 row_mask:0xa bank_mask:0xf
    v_add_f32_dpp v25, v25, v25 row_bcast:15 row_mask:0xa bank_mask:0xf
    v_add_f32_dpp v26, v26, v26 row_bcast:15 row_mask:0xa bank_mask:0xf
    v_add_f32_dpp v27, v27, v27 row_bcast:15 row_mask:0xa bank_mask:0xf
    v_add_f32_dpp v28, v28, v28 row_bcast:15 row_mask:0xa bank_mask:0xf
    v_add_f32_dpp v29, v29, v29 row_bcast:15 row_mask:0xa bank_mask:0xf
    v_add_f32_dpp v30, v30, v30 row_bcast:15 row_mask:0xa bank_mask:0xf
    v_add_f32_dpp v31, v31, v31 row_bcast:15 row_mask:0xa bank_mask:0xf
    s_nop 1
    v_add_f32_dpp v24, v24, v24 row_bcast:31 row_mask:0xc bank_mask:0xf
    v_add_f32_dpp v25, v25, v25 row_bcast:31 row_mask:0xc bank_mask:0xf
    v_add_f32_dpp v26, v26, v26 row_bcast:31 row_mask:0xc bank_mask:0xf
    v_add_f32_dpp v27, v27, v27 row_bcast:31 row_mask:0xc bank_mask:0xf
    v_add_f32_dpp v28, v28, v28 row_bcast:31 row_mask:0xc bank_mask:0xf
    v_add_f32_dpp v29, v29, v29 row_bcast:31 row_mask:0xc bank_mask:0xf
    v_add_f32_dpp v30, v30, v30 row_bcast:31 row_mask:0xc bank_mask:0xf
    v_add_f32_dpp v31, v31, v31 row_bcast:31 row_mask:0xc bank_mask:0xf
    s_nop 1
    v_readlane_b32 s56, v24, 63
    v_readlane_b32 s57, v25, 63
    v_readlane_b32 s58, v26, 63
    v_readlane_b32 s59, v27, 63
    v_readlane_b32 s60, v28, 63
    v_readlane_b32 s61, v29, 63
    v_readlane_b32 s62, v30, 63
    v_readlane_b32 s63, v31, 63
    s_nop 3
    v_writelane_b32 v32, s56, 0
    v_writelane_b32 v32, s57, 1
    v_writelane_b32 v32, s58, 2
    v_writelane_b32 v32, s59, 3
    v_writelane_b32 v32, s60, 4
    v_writelane_b32 v32, s61, 5
    v_writelane_b32 v32, s62, 6
    v_writelane_b32 v32, s63, 7
    s_nop 1
    v_cvt_pk_bf16_f32 v32, v32, v32
    v_and_b32 v32, 0xffff0000, v32
    v_mul_f32 v32, 0xbfb8aa3b, v32
    v_exp_f32 v32, v32
    s_nop 0
    v_add_f32 v32, 1.0, v32
    v_rcp_f32 v32, v32
    s_nop 0
    v_cvt_pk_bf16_f32 v32, v32, v32
    v_and_b32 v32, 0xffff0000, v32
    v_sub_f32 v33, 1.0, v32
    v_cvt_pk_bf16_f32 v33, v33, v33
    v_and_b32 v33, 0xffff0000, v33
    v_lshlrev_b32 v4, 3, v1
    s_lshl_b32 s69, s68, 3
    s_add_u32 s69, s69, 11272192
    s_mov_b64 exec, 0xff
    buffer_store_dwordx2 v[32:33], v4, s[52:55], s69 offen sc1
    s_mov_b64 exec, -1
    s_add_u32 s68, s68, 8
    s_and_b32 s69, s68, 31
    s_cbranch_scc1 Li_gate
    v_mov_b32 v4, 0
    global_load_dword v4, v4, s[44:45]
    s_waitcnt vmcnt(0)
    v_readfirstlane_b32 s79, v4
    s_ff1_i32_b32 s79, s79
    s_cmp_ge_i32 s79, 4
    s_cbranch_scc1 Ltag4
    s_mov_b32 s76, 40000
    v_mov_b32 v20, 0
Ltag4p:
    global_load_dword v4, v20, s[44:45] sc1
    s_sub_u32 s76, s76, 1
    s_waitcnt vmcnt(0)
    v_readfirstlane_b32 s79, v4
    s_ff1_i32_b32 s79, s79
    s_cmp_ge_i32 s79, 4
    s_cbranch_scc1 Ltag4
    s_sleep 12
    s_cmp_lg_u32 s76, 0
    s_cbranch_scc1 Ltag4p
Ltag4:
    s_mov_b32 s79, 16
    v_mov_b32 v4, s79
    v_mov_b32 v5, s64
    s_mov_b64 exec, 1
    global_store_dword v5, v4, s[46:47] sc1
    s_mov_b64 exec, -1
    s_branch Lp2_aux
Li_hi:
    s_waitcnt lgkmcnt(0)
    s_cmp_lg_u32 s3, 4
    s_cbranch_scc1 Li_noclr
    s_sub_u32 s68, s2, 240
    s_mul_i32 s68, s68, 8704
    s_add_u32 s68, s68, 11288576
    v_lshl_add_u32 v8, v1, 7, s68
    v_and_b32 v9, 3, v1
    v_or_b32 v9, 64, v9
    v_lshl_add_u32 v9, v9, 7, s68
    v_mov_b32 v10, 0
    v_mov_b32 v11, 1
    global_store_dword v8, v10, s[46:47] sc1
    global_store_dword v9, v10, s[46:47] sc1
    s_waitcnt vmcnt(0)
    s_mov_b64 exec, 1
    global_atomic_add v10, v11, s[44:45] sc1
    s_mov_b64 exec, -1
Li_noclr:
    s_sub_u32 s77, s3, 4
    s_bfe_u32 s76, s97, 0x30003
    s_mul_i32 s91, s77, 458752
    s_lshl_b32 s80, s76, 7
    s_add_u32 s91, s91, s80
    v_lshrrev_b32 v44, 3, v1
    v_lshlrev_b32 v44, 10, v44
    v_bfe_u32 v45, v1, 4, 1
    v_lshlrev_b32 v45, 2, v45
    v_and_b32 v6, 7, v1
    v_xor_b32 v45, v45, v6
    v_lshl_add_u32 v44, v45, 4, v44
    v_add_u32 v44, s91, v44
    v_add_u32 v45, 0x2000, v44
    s_lshr_b32 s80, s97, 6
    s_lshl_b32 s80, s80, 1
    s_add_u32 s80, s80, s76
    s_cmp_ge_u32 s80, 7
    s_cselect_b32 s81, 7, 0
    s_sub_u32 s80, s80, s81
    s_lshl_b32 s80, s80, 12
    s_add_u32 s81, s80, 4096
    s_cmp_eq_u32 s81, 28672
    s_cselect_b32 s81, 0, s81
    s_add_u32 s82, s81, 4096
    s_cmp_eq_u32 s82, 28672
    s_cselect_b32 s82, 0, s82
    s_add_u32 s83, s82, 4096
    s_cmp_eq_u32 s83, 28672
    s_cselect_b32 s83, 0, s83
    s_add_u32 s84, s83, 4096
    s_cmp_eq_u32 s84, 28672
    s_cselect_b32 s84, 0, s84
    s_add_u32 s85, s84, 4096
    s_cmp_eq_u32 s85, 28672
    s_cselect_b32 s85, 0, s85
    s_add_u32 s86, s85, 4096
    s_cmp_eq_u32 s86, 28672
    s_cselect_b32 s86, 0, s86
    s_lshr_b32 s76, s77, 1
    v_bfe_u32 v43, v1, 2, 2
    v_lshrrev_b32 v6, 5, v1
    v_lshl_add_u32 v43, v6, 2, v43
    v_lshlrev_b32 v43, 7, v43
    v_bfe_u32 v6, v1, 3, 1
    v_xor_b32 v6, s76, v6
    v_lshl_add_u32 v43, v6, 6, v43
    v_bfe_u32 v6, v1, 4, 1
    v_lshl_add_u32 v43, v6, 5, v43
    v_and_b32 v6, 3, v1
    v_lshl_add_u32 v43, v6, 3, v43
    s_mul_i32 s90, s77, 40960
    s_add_u32 s87, s90, 8704
    s_add_u32 s88, s90, 29184
    s_mov_b32 s92, s36
    s_mov_b32 s93, s37
    s_mov_b32 s94, 1835008
    s_mov_b32 s95, 0x20000
    s_sub_u32 s68, s2, 240
    s_lshl_b32 s68, s68, 2
    s_add_u32 s68, s68, s3
    s_sub_u32 s68, s68, 4
    s_mul_i32 s68, s68, 28672
    v_lshlrev_b32 v4, 7, v1
    buffer_load_dword v244, v4, s[92:95], s68 offen
    s_add_u32 s68, s68, 8192
    buffer_load_dword v245, v4, s[92:95], s68 offen
    s_add_u32 s68, s68, 8192
    buffer_load_dword v246, v4, s[92:95], s68 offen
    s_add_u32 s68, s68, 8192
    buffer_load_dword v247, v4, s[92:95], s68 offen
Li_nopf:
    s_add_u32 m0, s87, 0
    s_lshl_b32 s91, s80, 4
    buffer_load_dwordx4 v44, s[92:95], s91 offen lds
    s_add_u32 m0, m0, 1024
    s_nop 0
    buffer_load_dwordx4 v45, s[92:95], s91 offen lds
    s_add_u32 m0, s87, 2048
    s_add_u32 s91, s91, 16384
    buffer_load_dwordx4 v44, s[92:95], s91 offen lds
    s_add_u32 m0, m0, 1024
    s_nop 0
    buffer_load_dwordx4 v45, s[92:95], s91 offen lds
    s_add_u32 m0, s87, 4096
    s_add_u32 s91, s91, 16384
    buffer_load_dwordx4 v44, s[92:95], s91 offen lds
    s_add_u32 m0, m0, 1024
    s_nop 0
    buffer_load_dwordx4 v45, s[92:95], s91 offen lds
    s_add_u32 m0, s87, 6144
    s_add_u32 s91, s91, 16384
    buffer_load_dwordx4 v44, s[92:95], s91 offen lds
    s_add_u32 m0, m0, 1024
    s_nop 0
    buffer_load_dwordx4 v45, s[92:95], s91 offen lds
    s_add_u32 m0, s87, 8192
    s_lshl_b32 s91, s81, 4
    buffer_load_dwordx4 v44, s[92:95], s91 offen lds
    s_add_u32 m0, m0, 1024
    s_nop 0
    buffer_load_dwordx4 v45, s[92:95], s91 offen lds
    s_add_u32 m0, s87, 10240
    s_add_u32 s91, s91, 16384
    buffer_load_dwordx4 v44, s[92:95], s91 offen lds
    s_add_u32 m0, m0, 1024
    s_nop 0
    buffer_load_dwordx4 v45, s[92:95], s91 offen lds
    s_add_u32 m0, s87, 12288
    s_add_u32 s91, s91, 16384
    buffer_load_dwordx4 v44, s[92:95], s91 offen lds
    s_add_u32 m0, m0, 1024
    s_nop 0
    buffer_load_dwordx4 v45, s[92:95], s91 offen lds
    s_add_u32 m0, s87, 14336
    s_add_u32 s91, s91, 16384
    buffer_load_dwordx4 v44, s[92:95], s91 offen lds
    s_add_u32 m0, m0, 1024
    s_nop 0
    buffer_load_dwordx4 v45, s[92:95], s91 offen lds
    s_add_u32 m0, s87, 16384
    s_lshl_b32 s91, s82, 4
    buffer_load_dwordx4 v44, s[92:95], s91 offen lds
    s_add_u32 m0, m0, 1024
    s_nop 0
    buffer_load_dwordx4 v45, s[92:95], s91 offen lds
    s_add_u32 m0, s87, 18432
    s_add_u32 s91, s91, 16384
    buffer_load_dwordx4 v44, s[92:95], s91 offen lds
    s_add_u32 m0, m0, 1024
    s_nop 0
    buffer_load_dwordx4 v45, s[92:95], s91 offen lds
    s_waitcnt vmcnt(0)
    v_add_u32 v240, s87, v43
    v_xor_b32 v241, 64, v240
    ds_read_b64_tr_b16 v[128:129], v240 offset:0
    ds_read_b64_tr_b16 v[130:131], v240 offset:1024
    ds_read_b64_tr_b16 v[132:133], v241 offset:0
    ds_read_b64_tr_b16 v[134:135], v241 offset:1024
    ds_read_b64_tr_b16 v[136:137], v240 offset:2048
    ds_read_b64_tr_b16 v[138:139], v240 offset:3072
    ds_read_b64_tr_b16 v[140:141], v241 offset:2048
    ds_read_b64_tr_b16 v[142:143], v241 offset:3072
    ds_read_b64_tr_b16 v[144:145], v240 offset:4096
    ds_read_b64_tr_b16 v[146:147], v240 offset:5120
    ds_read_b64_tr_b16 v[148:149], v241 offset:4096
    ds_read_b64_tr_b16 v[150:151], v241 offset:5120
    ds_read_b64_tr_b16 v[152:153], v240 offset:6144
    ds_read_b64_tr_b16 v[154:155], v240 offset:7168
    ds_read_b64_tr_b16 v[156:157], v241 offset:6144
    ds_read_b64_tr_b16 v[158:159], v241 offset:7168
    ds_read_b64_tr_b16 v[160:161], v240 offset:8192
    ds_read_b64_tr_b16 v[162:163], v240 offset:9216
    ds_read_b64_tr_b16 v[164:165], v241 offset:8192
    ds_read_b64_tr_b16 v[166:167], v241 offset:9216
    ds_read_b64_tr_b16 v[168:169], v240 offset:10240
    ds_read_b64_tr_b16 v[170:171], v240 offset:11264
    ds_read_b64_tr_b16 v[172:173], v241 offset:10240
    ds_read_b64_tr_b16 v[174:175], v241 offset:11264
    ds_read_b64_tr_b16 v[176:177], v240 offset:12288
    ds_read_b64_tr_b16 v[178:179], v240 offset:13312
    ds_read_b64_tr_b16 v[180:181], v241 offset:12288
    ds_read_b64_tr_b16 v[182:183], v241 offset:13312
    ds_read_b64_tr_b16 v[184:185], v240 offset:14336
    ds_read_b64_tr_b16 v[186:187], v240 offset:15360
    ds_read_b64_tr_b16 v[188:189], v241 offset:14336
    ds_read_b64_tr_b16 v[190:191], v241 offset:15360
    ds_read_b64_tr_b16 v[192:193], v240 offset:16384
    ds_read_b64_tr_b16 v[194:195], v240 offset:17408
    ds_read_b64_tr_b16 v[196:197], v241 offset:16384
    ds_read_b64_tr_b16 v[198:199], v241 offset:17408
    ds_read_b64_tr_b16 v[200:201], v240 offset:18432
    ds_read_b64_tr_b16 v[202:203], v240 offset:19456
    ds_read_b64_tr_b16 v[204:205], v241 offset:18432
    ds_read_b64_tr_b16 v[206:207], v241 offset:19456
    s_waitcnt lgkmcnt(0)
    s_add_u32 m0, s87, 12288
    s_lshl_b32 s91, s82, 4
    s_add_u32 s91, s91, 32768
    buffer_load_dwordx4 v44, s[92:95], s91 offen lds
    s_add_u32 m0, m0, 1024
    s_nop 0
    buffer_load_dwordx4 v45, s[92:95], s91 offen lds
    s_add_u32 m0, s87, 14336
    s_add_u32 s91, s91, 16384
    buffer_load_dwordx4 v44, s[92:95], s91 offen lds
    s_add_u32 m0, m0, 1024
    s_nop 0
    buffer_load_dwordx4 v45, s[92:95], s91 offen lds
    s_add_u32 m0, s87, 16384
    s_lshl_b32 s91, s83, 4
    buffer_load_dwordx4 v44, s[92:95], s91 offen lds
    s_add_u32 m0, m0, 1024
    s_nop 0
    buffer_load_dwordx4 v45, s[92:95], s91 offen lds
    s_add_u32 m0, s87, 18432
    s_add_u32 s91, s91, 16384
    buffer_load_dwordx4 v44, s[92:95], s91 offen lds
    s_add_u32 m0, m0, 1024
    s_nop 0
    buffer_load_dwordx4 v45, s[92:95], s91 offen lds
    s_add_u32 m0, s87, 0
    s_lshl_b32 s91, s83, 4
    s_add_u32 s91, s91, 32768
    buffer_load_dwordx4 v44, s[92:95], s91 offen lds
    s_add_u32 m0, m0, 1024
    s_nop 0
    buffer_load_dwordx4 v45, s[92:95], s91 offen lds
    s_add_u32 m0, s87, 2048
    s_add_u32 s91, s91, 16384
    buffer_load_dwordx4 v44, s[92:95], s91 offen lds
    s_add_u32 m0, m0, 1024
    s_nop 0
    buffer_load_dwordx4 v45, s[92:95], s91 offen lds
    s_add_u32 m0, s87, 4096
    s_lshl_b32 s91, s84, 4
    buffer_load_dwordx4 v44, s[92:95], s91 offen lds
    s_add_u32 m0, m0, 1024
    s_nop 0
    buffer_load_dwordx4 v45, s[92:95], s91 offen lds
    s_add_u32 m0, s87, 6144
    s_add_u32 s91, s91, 16384
    buffer_load_dwordx4 v44, s[92:95], s91 offen lds
    s_add_u32 m0, m0, 1024
    s_nop 0
    buffer_load_dwordx4 v45, s[92:95], s91 offen lds
    s_add_u32 m0, s87, 8192
    s_add_u32 s91, s91, 16384
    buffer_load_dwordx4 v44, s[92:95], s91 offen lds
    s_add_u32 m0, m0, 1024
    s_nop 0
    buffer_load_dwordx4 v45, s[92:95], s91 offen lds
    s_add_u32 m0, s87, 10240
    s_add_u32 s91, s91, 16384
    buffer_load_dwordx4 v44, s[92:95], s91 offen lds
    s_add_u32 m0, m0, 1024
    s_nop 0
    buffer_load_dwordx4 v45, s[92:95], s91 offen lds
    s_waitcnt vmcnt(0)
    v_add_u32 v240, s87, v43
    v_xor_b32 v241, 64, v240
    ds_read_b64_tr_b16 v[208:209], v240 offset:12288
    ds_read_b64_tr_b16 v[210:211], v240 offset:13312
    ds_read_b64_tr_b16 v[212:213], v241 offset:12288
    ds_read_b64_tr_b16 v[214:215], v241 offset:13312
    ds_read_b64_tr_b16 v[216:217], v240 offset:14336
    ds_read_b64_tr_b16 v[218:219], v240 offset:15360
    ds_read_b64_tr_b16 v[220:221], v241 offset:14336
    ds_read_b64_tr_b16 v[222:223], v241 offset:15360
    ds_read_b64_tr_b16 v[224:225], v240 offset:16384
    ds_read_b64_tr_b16 v[226:227], v240 offset:17408
    ds_read_b64_tr_b16 v[228:229], v241 offset:16384
    ds_read_b64_tr_b16 v[230:231], v241 offset:17408
    ds_read_b64_tr_b16 v[232:233], v240 offset:18432
    ds_read_b64_tr_b16 v[234:235], v240 offset:19456
    ds_read_b64_tr_b16 v[236:237], v241 offset:18432
    ds_read_b64_tr_b16 v[238:239], v241 offset:19456
    s_add_u32 m0, s87, 20480
    s_lshl_b32 s91, s86, 4
    buffer_load_dwordx4 v44, s[92:95], s91 offen lds
    s_add_u32 m0, m0, 1024
    s_nop 0
    buffer_load_dwordx4 v45, s[92:95], s91 offen lds
    s_add_u32 m0, s87, 22528
    s_add_u32 s91, s91, 16384
    buffer_load_dwordx4 v44, s[92:95], s91 offen lds
    s_add_u32 m0, m0, 1024
    s_nop 0
    buffer_load_dwordx4 v45, s[92:95], s91 offen lds
    s_add_u32 m0, s87, 24576
    s_add_u32 s91, s91, 16384
    buffer_load_dwordx4 v44, s[92:95], s91 offen lds
    s_add_u32 m0, m0, 1024
    s_nop 0
    buffer_load_dwordx4 v45, s[92:95], s91 offen lds
    s_add_u32 m0, s87, 26624
    s_add_u32 s91, s91, 16384
    buffer_load_dwordx4 v44, s[92:95], s91 offen lds
    s_add_u32 m0, m0, 1024
    s_nop 0
    buffer_load_dwordx4 v45, s[92:95], s91 offen lds
    s_waitcnt lgkmcnt(0)
    s_add_u32 m0, s87, 12288
    s_lshl_b32 s91, s85, 4
    buffer_load_dwordx4 v44, s[92:95], s91 offen lds
    s_add_u32 m0, m0, 1024
    s_nop 0
    buffer_load_dwordx4 v45, s[92:95], s91 offen lds
    s_add_u32 m0, s87, 14336
    s_add_u32 s91, s91, 16384
    buffer_load_dwordx4 v44, s[92:95], s91 offen lds
    s_add_u32 m0, m0, 1024
    s_nop 0
    buffer_load_dwordx4 v45, s[92:95], s91 offen lds
    s_add_u32 m0, s87, 16384
    s_add_u32 s91, s91, 16384
    buffer_load_dwordx4 v44, s[92:95], s91 offen lds
    s_add_u32 m0, m0, 1024
    s_nop 0
    buffer_load_dwordx4 v45, s[92:95], s91 offen lds
    s_add_u32 m0, s87, 18432
    s_add_u32 s91, s91, 16384
    buffer_load_dwordx4 v44, s[92:95], s91 offen lds
    s_add_u32 m0, m0, 1024
    s_nop 0
    buffer_load_dwordx4 v45, s[92:95], s91 offen lds
    s_branch Lp2_main
Lp2_aux:
    s_lshr_b32 s6, s97, 6
    s_lshl_b32 s7, s4, 2
    s_add_u32 s6, s6, s7
    s_bfe_u32 s7, s97, 0x30003
    s_lshr_b32 s11, s3, 1
    s_and_b32 s12, s3, 1
    s_lshl_b32 s13, s6, 1
    s_add_u32 s13, s13, s12
    s_lshl_b32 s13, s13, 5
    s_lshl_b32 s14, s7, 1
    s_add_u32 s14, s14, s11
    s_lshl_b32 s14, s14, 5
    v_and_b32 v7, 31, v1
    v_lshrrev_b32 v8, 5, v1
    v_add_u32 v7, s13, v7
    s_lshl_b32 s72, s14, 1
    v_lshlrev_b32 v2, 4, v1
    s_mov_b32 s48, s46
    s_mov_b32 s49, s47
    s_mov_b32 s50, 11427840
    s_mov_b32 s51, 0x20000
    s_load_dwordx16 s[52:67], s[38:39], s72
    v_lshlrev_b32 v9, 3, v7
    v_bfe_u32 v10, v7, 1, 2
    v_lshl_add_u32 v10, v8, 2, v10
    v_lshlrev_b32 v10, 12, v10
    v_lshrrev_b32 v11, 3, v7
    v_lshl_add_u32 v10, v11, 4, v10
    v_and_b32 v11, 1, v7
    v_lshl_add_u32 v10, v11, 3, v10
    s_lshl_b32 s15, s14, 12
    s_add_u32 s15, s15, 9175040
    s_add_u32 s68, s15, 32768
    s_add_u32 s69, s68, 32768
    s_add_u32 s70, s69, 32768
    s_mov_b32 s71, 11272192
    s_lshr_b32 s73, s6, 3
    s_lshl_b32 s73, s73, 9
    s_add_u32 s73, s73, s14
    s_lshl_b32 s73, s73, 5
    s_add_u32 s73, s73, 11354112
    v_and_b32 v3, 7, v1
    v_lshl_add_u32 v3, v3, 7, s73
    s_lshr_b32 s73, s13, 3
    s_lshl_b32 s73, s73, 5
    s_add_u32 s73, s73, 11419648
    v_mov_b32 v4, s73
    v_cmp_gt_u32 vcc, 48, v1
    v_add_u32 v12, s90, v2
    v_lshl_add_u32 v13, v1, 2, s90
    v_cndmask_b32 v3, v4, v3, vcc
    s_lshr_b32 s73, s6, 1
    s_lshl_b32 s73, s73, 5
    s_mul_i32 s74, s3, 7
    s_add_u32 s73, s73, s74
    s_lshl_b32 s73, s73, 7
    s_add_u32 s73, s73, 11288576
    v_cmp_gt_u32 vcc, 32, v1
    v_min_u32 v5, 6, v1
    v_lshl_add_u32 v5, v5, 7, s73
    v_mov_b32 v6, 0
    ds_write_b32 v13, v6 offset:40704
    v_cndmask_b32 v3, v3, v5, vcc
    s_waitcnt lgkmcnt(0)
    v_mov_b32 v24, s52
    v_mov_b32 v25, s53
    v_mov_b32 v26, s56
    v_mov_b32 v27, s57
    v_mov_b32 v28, s60
    v_mov_b32 v29, s61
    v_mov_b32 v30, s64
    v_mov_b32 v31, s65
    s_mov_b32 exec_lo, 0
    v_mov_b32 v24, s54
    v_mov_b32 v25, s55
    v_mov_b32 v26, s58
    v_mov_b32 v27, s59
    v_mov_b32 v28, s62
    v_mov_b32 v29, s63
    v_mov_b32 v30, s66
    v_mov_b32 v31, s67
    s_mov_b32 exec_lo, -1
    v_mov_b32 v6, 1
    s_barrier
    s_mov_b32 s76, 40000
Lp2_poll:
    global_load_dword v80, v3, s[46:47] sc1
    s_sub_u32 s76, s76, 1
    s_waitcnt vmcnt(0)
    v_cmp_ne_u32 vcc, s79, v80
    s_cmp_eq_u32 s76, 0
    s_cbranch_scc1 Lp2_pollx
    s_cmp_eq_u32 vcc_lo, 0
    s_cbranch_scc1 Lp2_pollx
    s_sleep 12
    s_branch Lp2_poll
Lp2_pollx:
    ds_write_b32 v13, v6 offset:40704
    s_cbranch_vccz Lp2_ready
    s_mov_b32 s76, 40000
Lpoll5:
    global_load_dword v4, v3, s[46:47] sc1
    s_sub_u32 s76, s76, 1
    s_waitcnt vmcnt(0)
    v_cmp_ne_u32 vcc, s79, v4
    s_cmp_eq_u32 s76, 0
    s_cbranch_scc1 Lpoll5x
    s_cbranch_vccz Lpoll5x
    s_sleep 12
    s_branch Lpoll5
Lpoll5x:
Lp2_ready:
    buffer_load_dwordx2 v[16:17], v10, s[48:51], s15 offen sc1
    buffer_load_dwordx2 v[18:19], v10, s[48:51], s68 offen sc1
    buffer_load_dwordx2 v[20:21], v10, s[48:51], s69 offen sc1
    buffer_load_dwordx2 v[22:23], v10, s[48:51], s70 offen sc1
    buffer_load_dwordx2 v[32:33], v9, s[48:51], s71 offen sc1
    v_lshlrev_b32 v56, 16, v24
    v_and_b32 v57, 0xffff0000, v24
    v_lshlrev_b32 v58, 16, v25
    v_and_b32 v59, 0xffff0000, v25
    v_lshlrev_b32 v60, 16, v26
    v_and_b32 v61, 0xffff0000, v26
    v_lshlrev_b32 v62, 16, v27
    v_and_b32 v63, 0xffff0000, v27
    v_lshlrev_b32 v64, 16, v28
    v_and_b32 v65, 0xffff0000, v28
    v_lshlrev_b32 v66, 16, v29
    v_and_b32 v67, 0xffff0000, v29
    v_lshlrev_b32 v68, 16, v30
    v_and_b32 v69, 0xffff0000, v30
    v_lshlrev_b32 v70, 16, v31
    v_and_b32 v71, 0xffff0000, v31
    s_waitcnt vmcnt(0)
    v_lshlrev_b32 v40, 16, v16
    v_and_b32 v41, 0xffff0000, v16
    v_lshlrev_b32 v42, 16, v17
    v_and_b32 v43, 0xffff0000, v17
    v_lshlrev_b32 v44, 16, v18
    v_and_b32 v45, 0xffff0000, v18
    v_lshlrev_b32 v46, 16, v19
    v_and_b32 v47, 0xffff0000, v19
    v_lshlrev_b32 v48, 16, v20
    v_and_b32 v49, 0xffff0000, v20
    v_lshlrev_b32 v50, 16, v21
    v_and_b32 v51, 0xffff0000, v21
    v_lshlrev_b32 v52, 16, v22
    v_and_b32 v53, 0xffff0000, v22
    v_lshlrev_b32 v54, 16, v23
    v_and_b32 v55, 0xffff0000, v23
    v_mul_f32 v40, v40, v32
    v_mul_f32 v41, v41, v32
    v_mul_f32 v42, v42, v32
    v_mul_f32 v43, v43, v32
    v_mul_f32 v44, v44, v32
    v_mul_f32 v45, v45, v32
    v_mul_f32 v46, v46, v32
    v_mul_f32 v47, v47, v32
    v_mul_f32 v48, v48, v32
    v_mul_f32 v49, v49, v32
    v_mul_f32 v50, v50, v32
    v_mul_f32 v51, v51, v32
    v_mul_f32 v52, v52, v32
    v_mul_f32 v53, v53, v32
    v_mul_f32 v54, v54, v32
    v_mul_f32 v55, v55, v32
    v_fmac_f32 v40, v56, v33
    v_fmac_f32 v41, v57, v33
    v_fmac_f32 v42, v58, v33
    v_fmac_f32 v43, v59, v33
    v_fmac_f32 v44, v60, v33
    v_fmac_f32 v45, v61, v33
    v_fmac_f32 v46, v62, v33
    v_fmac_f32 v47, v63, v33
    v_fmac_f32 v48, v64, v33
    v_fmac_f32 v49, v65, v33
    v_fmac_f32 v50, v66, v33
    v_fmac_f32 v51, v67, v33
    v_fmac_f32 v52, v68, v33
    v_fmac_f32 v53, v69, v33
    v_fmac_f32 v54, v70, v33
    v_fmac_f32 v55, v71, v33
    ds_write_b128 v12, v[40:43] offset:0
    ds_write_b128 v12, v[44:47] offset:1024
    ds_write_b128 v12, v[48:51] offset:2048
    ds_write_b128 v12, v[52:55] offset:3072
    ds_write_b32 v13, v33 offset:4096
    s_waitcnt lgkmcnt(0)
    s_barrier
    s_endpgm
Lp2_main:
    s_barrier
    s_sub_u32 s10, s3, 4
    s_lshr_b32 s6, s97, 6
    s_lshl_b32 s7, s4, 2
    s_add_u32 s6, s6, s7
    s_bfe_u32 s7, s97, 0x30003
    s_lshr_b32 s11, s10, 1
    s_and_b32 s12, s10, 1
    s_lshl_b32 s13, s6, 1
    s_add_u32 s13, s13, s12
    s_lshl_b32 s13, s13, 5
    s_lshl_b32 s14, s7, 1
    s_add_u32 s14, s14, s11
    s_lshl_b32 s14, s14, 5
    v_and_b32 v7, 31, v1
    v_lshrrev_b32 v8, 5, v1
    v_add_u32 v7, s13, v7
    s_lshl_b32 s72, s14, 1
    v_lshlrev_b32 v2, 4, v1
    s_mov_b32 s48, s46
    s_mov_b32 s49, s47
    s_mov_b32 s50, 11427840
    s_mov_b32 s51, 0x20000
    s_mov_b32 s52, s42
    s_mov_b32 s53, s43
    s_mov_b32 s54, 2097152
    s_mov_b32 s55, 0x20000
    s_mul_i32 s8, s10, 28672
    s_mul_i32 s9, s6, 229376
    s_add_u32 s9, s9, s8
    s_mul_i32 s13, s12, 114688
    s_sub_u32 s14, 114688, s13
    s_add_u32 s13, s13, s9
    s_add_u32 s14, s14, s9
    v_add_u32 v3, s13, v2
    v_add_u32 v4, s14, v2
    v_lshlrev_b32 v12, 10, v7
    v_lshl_add_u32 v12, v8, 4, v12
    v_add_u32 v12, s72, v12
    v_add_u32 v14, s87, v2
    s_xor_b32 s14, s10, 1
    s_mul_i32 s14, s14, 40960
    s_add_u32 s14, s14, 8704
    v_add_u32 v7, s14, v2
    s_xor_b32 s14, s10, 2
    s_mul_i32 s14, s14, 40960
    s_add_u32 s14, s14, 8704
    v_add_u32 v8, s14, v2
    s_xor_b32 s14, s10, 3
    s_mul_i32 s14, s14, 40960
    s_add_u32 s14, s14, 8704
    v_add_u32 v9, s14, v2
    v_add_u32 v10, s87, v43
    v_xor_b32 v11, 64, v10
    v_add_u32 v2, s90, v2
    v_lshl_add_u32 v13, v1, 2, s90
    s_mov_b32 s76, 640000
Lp2_wait:
    ds_read_b32 v6, v13 offset:40704
    s_sub_u32 s76, s76, 1
    s_waitcnt lgkmcnt(0)
    v_cmp_ne_u32 vcc, 1, v6
    s_cmp_eq_u32 s76, 0
    s_cbranch_scc1 Lp2_go
    s_cbranch_vccz Lp2_go
    s_sleep 1
    s_branch Lp2_wait
Lp2_go:
    buffer_load_dwordx4 v[16:19], v3, s[48:51], s80 offen offset:0 sc1
    buffer_load_dwordx4 v[20:23], v4, s[48:51], s80 offen offset:0 sc1
    buffer_load_dwordx4 v[24:27], v3, s[48:51], s80 offen offset:1024 sc1
    buffer_load_dwordx4 v[28:31], v4, s[48:51], s80 offen offset:1024 sc1
    buffer_load_dwordx4 v[32:35], v3, s[48:51], s80 offen offset:2048 sc1
    buffer_load_dwordx4 v[36:39], v4, s[48:51], s80 offen offset:2048 sc1
    buffer_load_dwordx4 v[48:51], v3, s[48:51], s80 offen offset:3072 sc1
    buffer_load_dwordx4 v[52:55], v4, s[48:51], s80 offen offset:3072 sc1
    buffer_load_dwordx4 v[56:59], v3, s[48:51], s81 offen offset:0 sc1
    buffer_load_dwordx4 v[60:63], v4, s[48:51], s81 offen offset:0 sc1
    s_waitcnt vmcnt(8)
    v_mfma_f32_32x32x16_bf16 v[64:79], v[128:131], v[16:19], 0
    v_mfma_f32_32x32x16_bf16 v[80:95], v[128:131], v[20:23], 0
    v_mfma_f32_32x32x16_bf16 v[96:111], v[132:135], v[16:19], 0
    v_mfma_f32_32x32x16_bf16 v[112:127], v[132:135], v[20:23], 0
    buffer_load_dwordx4 v[16:19], v3, s[48:51], s81 offen offset:1024 sc1
    buffer_load_dwordx4 v[20:23], v4, s[48:51], s81 offen offset:1024 sc1
    s_waitcnt vmcnt(8)
    v_mfma_f32_32x32x16_bf16 v[64:79], v[136:139], v[24:27], v[64:79]
    v_mfma_f32_32x32x16_bf16 v[80:95], v[136:139], v[28:31], v[80:95]
    v_mfma_f32_32x32x16_bf16 v[96:111], v[140:143], v[24:27], v[96:111]
    v_mfma_f32_32x32x16_bf16 v[112:127], v[140:143], v[28:31], v[112:127]
    buffer_load_dwordx4 v[24:27], v3, s[48:51], s81 offen offset:2048 sc1
    buffer_load_dwordx4 v[28:31], v4, s[48:51], s81 offen offset:2048 sc1
    s_waitcnt vmcnt(8)
    v_mfma_f32_32x32x16_bf16 v[64:79], v[144:147], v[32:35], v[64:79]
    v_mfma_f32_32x32x16_bf16 v[80:95], v[144:147], v[36:39], v[80:95]
    v_mfma_f32_32x32x16_bf16 v[96:111], v[148:151], v[32:35], v[96:111]
    v_mfma_f32_32x32x16_bf16 v[112:127], v[148:151], v[36:39], v[112:127]
    buffer_load_dwordx4 v[32:35], v3, s[48:51], s81 offen offset:3072 sc1
    buffer_load_dwordx4 v[36:39], v4, s[48:51], s81 offen offset:3072 sc1
    s_waitcnt vmcnt(8)
    v_mfma_f32_32x32x16_bf16 v[64:79], v[152:155], v[48:51], v[64:79]
    v_mfma_f32_32x32x16_bf16 v[80:95], v[152:155], v[52:55], v[80:95]
    v_mfma_f32_32x32x16_bf16 v[96:111], v[156:159], v[48:51], v[96:111]
    v_mfma_f32_32x32x16_bf16 v[112:127], v[156:159], v[52:55], v[112:127]
    buffer_load_dwordx4 v[48:51], v3, s[48:51], s82 offen offset:0 sc1
    buffer_load_dwordx4 v[52:55], v4, s[48:51], s82 offen offset:0 sc1
    s_waitcnt vmcnt(8)
    v_mfma_f32_32x32x16_bf16 v[64:79], v[160:163], v[56:59], v[64:79]
    v_mfma_f32_32x32x16_bf16 v[80:95], v[160:163], v[60:63], v[80:95]
    v_mfma_f32_32x32x16_bf16 v[96:111], v[164:167], v[56:59], v[96:111]
    v_mfma_f32_32x32x16_bf16 v[112:127], v[164:167], v[60:63], v[112:127]
    buffer_load_dwordx4 v[56:59], v3, s[48:51], s82 offen offset:1024 sc1
    buffer_load_dwordx4 v[60:63], v4, s[48:51], s82 offen offset:1024 sc1
    s_waitcnt vmcnt(8)
    v_mfma_f32_32x32x16_bf16 v[64:79], v[168:171], v[16:19], v[64:79]
    v_mfma_f32_32x32x16_bf16 v[80:95], v[168:171], v[20:23], v[80:95]
    v_mfma_f32_32x32x16_bf16 v[96:111], v[172:175], v[16:19], v[96:111]
    v_mfma_f32_32x32x16_bf16 v[112:127], v[172:175], v[20:23], v[112:127]
    buffer_load_dwordx4 v[16:19], v3, s[48:51], s82 offen offset:2048 sc1
    buffer_load_dwordx4 v[20:23], v4, s[48:51], s82 offen offset:2048 sc1
    s_waitcnt vmcnt(8)
    v_mfma_f32_32x32x16_bf16 v[64:79], v[176:179], v[24:27], v[64:79]
    v_mfma_f32_32x32x16_bf16 v[80:95], v[176:179], v[28:31], v[80:95]
    v_mfma_f32_32x32x16_bf16 v[96:111], v[180:183], v[24:27], v[96:111]
    v_mfma_f32_32x32x16_bf16 v[112:127], v[180:183], v[28:31], v[112:127]
    buffer_load_dwordx4 v[24:27], v3, s[48:51], s82 offen offset:3072 sc1
    buffer_load_dwordx4 v[28:31], v4, s[48:51], s82 offen offset:3072 sc1
    s_waitcnt vmcnt(8)
    v_mfma_f32_32x32x16_bf16 v[64:79], v[184:187], v[32:35], v[64:79]
    v_mfma_f32_32x32x16_bf16 v[80:95], v[184:187], v[36:39], v[80:95]
    v_mfma_f32_32x32x16_bf16 v[96:111], v[188:191], v[32:35], v[96:111]
    v_mfma_f32_32x32x16_bf16 v[112:127], v[188:191], v[36:39], v[112:127]
    buffer_load_dwordx4 v[32:35], v3, s[48:51], s83 offen offset:0 sc1
    buffer_load_dwordx4 v[36:39], v4, s[48:51], s83 offen offset:0 sc1
    s_waitcnt vmcnt(8)
    v_mfma_f32_32x32x16_bf16 v[64:79], v[192:195], v[48:51], v[64:79]
    v_mfma_f32_32x32x16_bf16 v[80:95], v[192:195], v[52:55], v[80:95]
    v_mfma_f32_32x32x16_bf16 v[96:111], v[196:199], v[48:51], v[96:111]
    v_mfma_f32_32x32x16_bf16 v[112:127], v[196:199], v[52:55], v[112:127]
    buffer_load_dwordx4 v[48:51], v3, s[48:51], s83 offen offset:1024 sc1
    buffer_load_dwordx4 v[52:55], v4, s[48:51], s83 offen offset:1024 sc1
    s_waitcnt vmcnt(8)
    v_mfma_f32_32x32x16_bf16 v[64:79], v[200:203], v[56:59], v[64:79]
    v_mfma_f32_32x32x16_bf16 v[80:95], v[200:203], v[60:63], v[80:95]
    v_mfma_f32_32x32x16_bf16 v[96:111], v[204:207], v[56:59], v[96:111]
    v_mfma_f32_32x32x16_bf16 v[112:127], v[204:207], v[60:63], v[112:127]
    buffer_load_dwordx4 v[56:59], v3, s[48:51], s83 offen offset:2048 sc1
    buffer_load_dwordx4 v[60:63], v4, s[48:51], s83 offen offset:2048 sc1
    s_waitcnt vmcnt(8)
    v_mfma_f32_32x32x16_bf16 v[64:79], v[208:211], v[16:19], v[64:79]
    v_mfma_f32_32x32x16_bf16 v[80:95], v[208:211], v[20:23], v[80:95]
    v_mfma_f32_32x32x16_bf16 v[96:111], v[212:215], v[16:19], v[96:111]
    v_mfma_f32_32x32x16_bf16 v[112:127], v[212:215], v[20:23], v[112:127]
    buffer_load_dwordx4 v[16:19], v3, s[48:51], s83 offen offset:3072 sc1
    buffer_load_dwordx4 v[20:23], v4, s[48:51], s83 offen offset:3072 sc1
    s_waitcnt vmcnt(8)
    v_mfma_f32_32x32x16_bf16 v[64:79], v[216:219], v[24:27], v[64:79]
    v_mfma_f32_32x32x16_bf16 v[80:95], v[216:219], v[28:31], v[80:95]
    v_mfma_f32_32x32x16_bf16 v[96:111], v[220:223], v[24:27], v[96:111]
    v_mfma_f32_32x32x16_bf16 v[112:127], v[220:223], v[28:31], v[112:127]
    buffer_load_dwordx4 v[24:27], v3, s[48:51], s84 offen offset:0 sc1
    buffer_load_dwordx4 v[28:31], v4, s[48:51], s84 offen offset:0 sc1
    s_waitcnt vmcnt(8)
    v_mfma_f32_32x32x16_bf16 v[64:79], v[224:227], v[32:35], v[64:79]
    v_mfma_f32_32x32x16_bf16 v[80:95], v[224:227], v[36:39], v[80:95]
    v_mfma_f32_32x32x16_bf16 v[96:111], v[228:231], v[32:35], v[96:111]
    v_mfma_f32_32x32x16_bf16 v[112:127], v[228:231], v[36:39], v[112:127]
    buffer_load_dwordx4 v[32:35], v3, s[48:51], s84 offen offset:1024 sc1
    buffer_load_dwordx4 v[36:39], v4, s[48:51], s84 offen offset:1024 sc1
    ds_read_b64_tr_b16 v[240:241], v10 offset:0
    ds_read_b64_tr_b16 v[242:243], v10 offset:1024
    ds_read_b64_tr_b16 v[244:245], v11 offset:0
    ds_read_b64_tr_b16 v[246:247], v11 offset:1024
    s_waitcnt vmcnt(8)
    v_mfma_f32_32x32x16_bf16 v[64:79], v[232:235], v[48:51], v[64:79]
    v_mfma_f32_32x32x16_bf16 v[80:95], v[232:235], v[52:55], v[80:95]
    v_mfma_f32_32x32x16_bf16 v[96:111], v[236:239], v[48:51], v[96:111]
    v_mfma_f32_32x32x16_bf16 v[112:127], v[236:239], v[52:55], v[112:127]
    buffer_load_dwordx4 v[48:51], v3, s[48:51], s84 offen offset:2048 sc1
    buffer_load_dwordx4 v[52:55], v4, s[48:51], s84 offen offset:2048 sc1
    ds_read_b64_tr_b16 v[248:249], v10 offset:2048
    ds_read_b64_tr_b16 v[250:251], v10 offset:3072
    ds_read_b64_tr_b16 v[252:253], v11 offset:2048
    ds_read_b64_tr_b16 v[254:255], v11 offset:3072
    s_waitcnt vmcnt(8) lgkmcnt(4)
    v_mfma_f32_32x32x16_bf16 v[64:79], v[240:243], v[56:59], v[64:79]
    v_mfma_f32_32x32x16_bf16 v[80:95], v[240:243], v[60:63], v[80:95]
    v_mfma_f32_32x32x16_bf16 v[96:111], v[244:247], v[56:59], v[96:111]
    v_mfma_f32_32x32x16_bf16 v[112:127], v[244:247], v[60:63], v[112:127]
    buffer_load_dwordx4 v[56:59], v3, s[48:51], s84 offen offset:3072 sc1
    buffer_load_dwordx4 v[60:63], v4, s[48:51], s84 offen offset:3072 sc1
    ds_read_b64_tr_b16 v[240:241], v10 offset:4096
    ds_read_b64_tr_b16 v[242:243], v10 offset:5120
    ds_read_b64_tr_b16 v[244:245], v11 offset:4096
    ds_read_b64_tr_b16 v[246:247], v11 offset:5120
    s_waitcnt vmcnt(8) lgkmcnt(4)
    v_mfma_f32_32x32x16_bf16 v[64:79], v[248:251], v[16:19], v[64:79]
    v_mfma_f32_32x32x16_bf16 v[80:95], v[248:251], v[20:23], v[80:95]
    v_mfma_f32_32x32x16_bf16 v[96:111], v[252:255], v[16:19], v[96:111]
    v_mfma_f32_32x32x16_bf16 v[112:127], v[252:255], v[20:23], v[112:127]
    buffer_load_dwordx4 v[16:19], v3, s[48:51], s85 offen offset:0 sc1
    buffer_load_dwordx4 v[20:23], v4, s[48:51], s85 offen offset:0 sc1
    ds_read_b64_tr_b16 v[248:249], v10 offset:6144
    ds_read_b64_tr_b16 v[250:251], v10 offset:7168
    ds_read_b64_tr_b16 v[252:253], v11 offset:6144
    ds_read_b64_tr_b16 v[254:255], v11 offset:7168
    s_waitcnt vmcnt(8) lgkmcnt(4)
    v_mfma_f32_32x32x16_bf16 v[64:79], v[240:243], v[24:27], v[64:79]
    v_mfma_f32_32x32x16_bf16 v[80:95], v[240:243], v[28:31], v[80:95]
    v_mfma_f32_32x32x16_bf16 v[96:111], v[244:247], v[24:27], v[96:111]
    v_mfma_f32_32x32x16_bf16 v[112:127], v[244:247], v[28:31], v[112:127]
    buffer_load_dwordx4 v[24:27], v3, s[48:51], s85 offen offset:1024 sc1
    buffer_load_dwordx4 v[28:31], v4, s[48:51], s85 offen offset:1024 sc1
    ds_read_b64_tr_b16 v[240:241], v10 offset:8192
    ds_read_b64_tr_b16 v[242:243], v10 offset:9216
    ds_read_b64_tr_b16 v[244:245], v11 offset:8192
    ds_read_b64_tr_b16 v[246:247], v11 offset:9216
    s_waitcnt vmcnt(8) lgkmcnt(4)
    v_mfma_f32_32x32x16_bf16 v[64:79], v[248:251], v[32:35], v[64:79]
    v_mfma_f32_32x32x16_bf16 v[80:95], v[248:251], v[36:39], v[80:95]
    v_mfma_f32_32x32x16_bf16 v[96:111], v[252:255], v[32:35], v[96:111]
    v_mfma_f32_32x32x16_bf16 v[112:127], v[252:255], v[36:39], v[112:127]
    buffer_load_dwordx4 v[32:35], v3, s[48:51], s85 offen offset:2048 sc1
    buffer_load_dwordx4 v[36:39], v4, s[48:51], s85 offen offset:2048 sc1
    ds_read_b64_tr_b16 v[248:249], v10 offset:10240
    ds_read_b64_tr_b16 v[250:251], v10 offset:11264
    ds_read_b64_tr_b16 v[252:253], v11 offset:10240
    ds_read_b64_tr_b16 v[254:255], v11 offset:11264
    s_waitcnt vmcnt(8) lgkmcnt(4)
    v_mfma_f32_32x32x16_bf16 v[64:79], v[240:243], v[48:51], v[64:79]
    v_mfma_f32_32x32x16_bf16 v[80:95], v[240:243], v[52:55], v[80:95]
    v_mfma_f32_32x32x16_bf16 v[96:111], v[244:247], v[48:51], v[96:111]
    v_mfma_f32_32x32x16_bf16 v[112:127], v[244:247], v[52:55], v[112:127]
    buffer_load_dwordx4 v[48:51], v3, s[48:51], s85 offen offset:3072 sc1
    buffer_load_dwordx4 v[52:55], v4, s[48:51], s85 offen offset:3072 sc1
    ds_read_b64_tr_b16 v[240:241], v10 offset:12288
    ds_read_b64_tr_b16 v[242:243], v10 offset:13312
    ds_read_b64_tr_b16 v[244:245], v11 offset:12288
    ds_read_b64_tr_b16 v[246:247], v11 offset:13312
    s_waitcnt vmcnt(8) lgkmcnt(4)
    v_mfma_f32_32x32x16_bf16 v[64:79], v[248:251], v[56:59], v[64:79]
    v_mfma_f32_32x32x16_bf16 v[80:95], v[248:251], v[60:63], v[80:95]
    v_mfma_f32_32x32x16_bf16 v[96:111], v[252:255], v[56:59], v[96:111]
    v_mfma_f32_32x32x16_bf16 v[112:127], v[252:255], v[60:63], v[112:127]
    buffer_load_dwordx4 v[56:59], v3, s[48:51], s86 offen offset:0 sc1
    buffer_load_dwordx4 v[60:63], v4, s[48:51], s86 offen offset:0 sc1
    ds_read_b64_tr_b16 v[248:249], v10 offset:14336
    ds_read_b64_tr_b16 v[250:251], v10 offset:15360
    ds_read_b64_tr_b16 v[252:253], v11 offset:14336
    ds_read_b64_tr_b16 v[254:255], v11 offset:15360
    s_waitcnt vmcnt(8) lgkmcnt(4)
    v_mfma_f32_32x32x16_bf16 v[64:79], v[240:243], v[16:19], v[64:79]
    v_mfma_f32_32x32x16_bf16 v[80:95], v[240:243], v[20:23], v[80:95]
    v_mfma_f32_32x32x16_bf16 v[96:111], v[244:247], v[16:19], v[96:111]
    v_mfma_f32_32x32x16_bf16 v[112:127], v[244:247], v[20:23], v[112:127]
    buffer_load_dwordx4 v[16:19], v3, s[48:51], s86 offen offset:1024 sc1
    buffer_load_dwordx4 v[20:23], v4, s[48:51], s86 offen offset:1024 sc1
    ds_read_b64_tr_b16 v[240:241], v10 offset:16384
    ds_read_b64_tr_b16 v[242:243], v10 offset:17408
    ds_read_b64_tr_b16 v[244:245], v11 offset:16384
    ds_read_b64_tr_b16 v[246:247], v11 offset:17408
    s_waitcnt vmcnt(8) lgkmcnt(4)
    v_mfma_f32_32x32x16_bf16 v[64:79], v[248:251], v[24:27], v[64:79]
    v_mfma_f32_32x32x16_bf16 v[80:95], v[248:251], v[28:31], v[80:95]
    v_mfma_f32_32x32x16_bf16 v[96:111], v[252:255], v[24:27], v[96:111]
    v_mfma_f32_32x32x16_bf16 v[112:127], v[252:255], v[28:31], v[112:127]
    buffer_load_dwordx4 v[24:27], v3, s[48:51], s86 offen offset:2048 sc1
    buffer_load_dwordx4 v[28:31], v4, s[48:51], s86 offen offset:2048 sc1
    ds_read_b64_tr_b16 v[248:249], v10 offset:18432
    ds_read_b64_tr_b16 v[250:251], v10 offset:19456
    ds_read_b64_tr_b16 v[252:253], v11 offset:18432
    ds_read_b64_tr_b16 v[254:255], v11 offset:19456
    s_waitcnt vmcnt(8) lgkmcnt(4)
    v_mfma_f32_32x32x16_bf16 v[64:79], v[240:243], v[32:35], v[64:79]
    v_mfma_f32_32x32x16_bf16 v[80:95], v[240:243], v[36:39], v[80:95]
    v_mfma_f32_32x32x16_bf16 v[96:111], v[244:247], v[32:35], v[96:111]
    v_mfma_f32_32x32x16_bf16 v[112:127], v[244:247], v[36:39], v[112:127]
    buffer_load_dwordx4 v[32:35], v3, s[48:51], s86 offen offset:3072 sc1
    buffer_load_dwordx4 v[36:39], v4, s[48:51], s86 offen offset:3072 sc1
    ds_read_b64_tr_b16 v[240:241], v10 offset:20480
    ds_read_b64_tr_b16 v[242:243], v10 offset:21504
    ds_read_b64_tr_b16 v[244:245], v11 offset:20480
    ds_read_b64_tr_b16 v[246:247], v11 offset:21504
    s_waitcnt vmcnt(8) lgkmcnt(4)
    v_mfma_f32_32x32x16_bf16 v[64:79], v[248:251], v[48:51], v[64:79]
    v_mfma_f32_32x32x16_bf16 v[80:95], v[248:251], v[52:55], v[80:95]
    v_mfma_f32_32x32x16_bf16 v[96:111], v[252:255], v[48:51], v[96:111]
    v_mfma_f32_32x32x16_bf16 v[112:127], v[252:255], v[52:55], v[112:127]
    ds_read_b64_tr_b16 v[248:249], v10 offset:22528
    ds_read_b64_tr_b16 v[250:251], v10 offset:23552
    ds_read_b64_tr_b16 v[252:253], v11 offset:22528
    ds_read_b64_tr_b16 v[254:255], v11 offset:23552
    s_waitcnt vmcnt(6) lgkmcnt(4)
    v_mfma_f32_32x32x16_bf16 v[64:79], v[240:243], v[56:59], v[64:79]
    v_mfma_f32_32x32x16_bf16 v[80:95], v[240:243], v[60:63], v[80:95]
    v_mfma_f32_32x32x16_bf16 v[96:111], v[244:247], v[56:59], v[96:111]
    v_mfma_f32_32x32x16_bf16 v[112:127], v[244:247], v[60:63], v[112:127]
    ds_read_b64_tr_b16 v[240:241], v10 offset:24576
    ds_read_b64_tr_b16 v[242:243], v10 offset:25600
    ds_read_b64_tr_b16 v[244:245], v11 offset:24576
    ds_read_b64_tr_b16 v[246:247], v11 offset:25600
    s_waitcnt vmcnt(4) lgkmcnt(4)
    v_mfma_f32_32x32x16_bf16 v[64:79], v[248:251], v[16:19], v[64:79]
    v_mfma_f32_32x32x16_bf16 v[80:95], v[248:251], v[20:23], v[80:95]
    v_mfma_f32_32x32x16_bf16 v[96:111], v[252:255], v[16:19], v[96:111]
    v_mfma_f32_32x32x16_bf16 v[112:127], v[252:255], v[20:23], v[112:127]
    ds_read_b64_tr_b16 v[248:249], v10 offset:26624
    ds_read_b64_tr_b16 v[250:251], v10 offset:27648
    ds_read_b64_tr_b16 v[252:253], v11 offset:26624
    ds_read_b64_tr_b16 v[254:255], v11 offset:27648
    s_waitcnt vmcnt(2) lgkmcnt(4)
    v_mfma_f32_32x32x16_bf16 v[64:79], v[240:243], v[24:27], v[64:79]
    v_mfma_f32_32x32x16_bf16 v[80:95], v[240:243], v[28:31], v[80:95]
    v_mfma_f32_32x32x16_bf16 v[96:111], v[244:247], v[24:27], v[96:111]
    v_mfma_f32_32x32x16_bf16 v[112:127], v[244:247], v[28:31], v[112:127]
    s_waitcnt vmcnt(0) lgkmcnt(0)
    v_mfma_f32_32x32x16_bf16 v[64:79], v[248:251], v[32:35], v[64:79]
    v_mfma_f32_32x32x16_bf16 v[80:95], v[248:251], v[36:39], v[80:95]
    v_mfma_f32_32x32x16_bf16 v[96:111], v[252:255], v[32:35], v[96:111]
    v_mfma_f32_32x32x16_bf16 v[112:127], v[252:255], v[36:39], v[112:127]
    s_nop 7
    s_nop 1
    ds_write_b128 v14, v[80:83] offset:0
    ds_write_b128 v14, v[84:87] offset:1024
    ds_write_b128 v14, v[88:91] offset:2048
    ds_write_b128 v14, v[92:95] offset:3072
    ds_write_b128 v14, v[96:99] offset:4096
    ds_write_b128 v14, v[100:103] offset:5120
    ds_write_b128 v14, v[104:107] offset:6144
    ds_write_b128 v14, v[108:111] offset:7168
    ds_write_b128 v14, v[112:115] offset:8192
    ds_write_b128 v14, v[116:119] offset:9216
    ds_write_b128 v14, v[120:123] offset:10240
    ds_write_b128 v14, v[124:127] offset:11264
    s_waitcnt lgkmcnt(0)
    s_barrier
    ds_read_b128 v[128:131], v7 offset:0
    ds_read_b128 v[132:135], v7 offset:1024
    ds_read_b128 v[136:139], v7 offset:2048
    ds_read_b128 v[140:143], v7 offset:3072
    ds_read_b128 v[144:147], v8 offset:4096
    ds_read_b128 v[148:151], v8 offset:5120
    ds_read_b128 v[152:155], v8 offset:6144
    ds_read_b128 v[156:159], v8 offset:7168
    ds_read_b128 v[160:163], v9 offset:8192
    ds_read_b128 v[164:167], v9 offset:9216
    ds_read_b128 v[168:171], v9 offset:10240
    ds_read_b128 v[172:175], v9 offset:11264
    s_waitcnt lgkmcnt(8)
    ds_read_b128 v[176:179], v2 offset:0
    ds_read_b128 v[180:183], v2 offset:1024
    ds_read_b128 v[184:187], v2 offset:2048
    ds_read_b128 v[188:191], v2 offset:3072
    ds_read_b32 v6, v13 offset:4096
    v_pk_add_f32 v[64:65], v[64:65], v[128:129]
    v_pk_add_f32 v[66:67], v[66:67], v[130:131]
    v_pk_add_f32 v[68:69], v[68:69], v[132:133]
    v_pk_add_f32 v[70:71], v[70:71], v[134:135]
    v_pk_add_f32 v[72:73], v[72:73], v[136:137]
    v_pk_add_f32 v[74:75], v[74:75], v[138:139]
    v_pk_add_f32 v[76:77], v[76:77], v[140:141]
    v_pk_add_f32 v[78:79], v[78:79], v[142:143]
    s_waitcnt lgkmcnt(9)
    v_pk_add_f32 v[64:65], v[64:65], v[144:145]
    v_pk_add_f32 v[66:67], v[66:67], v[146:147]
    v_pk_add_f32 v[68:69], v[68:69], v[148:149]
    v_pk_add_f32 v[70:71], v[70:71], v[150:151]
    v_pk_add_f32 v[72:73], v[72:73], v[152:153]
    v_pk_add_f32 v[74:75], v[74:75], v[154:155]
    v_pk_add_f32 v[76:77], v[76:77], v[156:157]
    v_pk_add_f32 v[78:79], v[78:79], v[158:159]
    s_waitcnt lgkmcnt(5)
    v_pk_add_f32 v[64:65], v[64:65], v[160:161]
    v_pk_add_f32 v[66:67], v[66:67], v[162:163]
    v_pk_add_f32 v[68:69], v[68:69], v[164:165]
    v_pk_add_f32 v[70:71], v[70:71], v[166:167]
    v_pk_add_f32 v[72:73], v[72:73], v[168:169]
    v_pk_add_f32 v[74:75], v[74:75], v[170:171]
    v_pk_add_f32 v[76:77], v[76:77], v[172:173]
    v_pk_add_f32 v[78:79], v[78:79], v[174:175]
    s_waitcnt lgkmcnt(0)
    v_fmac_f32 v176, v64, v6
    v_fmac_f32 v177, v65, v6
    v_fmac_f32 v178, v66, v6
    v_fmac_f32 v179, v67, v6
    v_fmac_f32 v180, v68, v6
    v_fmac_f32 v181, v69, v6
    v_fmac_f32 v182, v70, v6
    v_fmac_f32 v183, v71, v6
    v_fmac_f32 v184, v72, v6
    v_fmac_f32 v185, v73, v6
    v_fmac_f32 v186, v74, v6
    v_fmac_f32 v187, v75, v6
    v_fmac_f32 v188, v76, v6
    v_fmac_f32 v189, v77, v6
    v_fmac_f32 v190, v78, v6
    v_fmac_f32 v191, v79, v6
    v_cvt_pk_bf16_f32 v16, v176, v177
    v_cvt_pk_bf16_f32 v17, v178, v179
    v_cvt_pk_bf16_f32 v18, v180, v181
    v_cvt_pk_bf16_f32 v19, v182, v183
    v_cvt_pk_bf16_f32 v20, v184, v185
    v_cvt_pk_bf16_f32 v21, v186, v187
    v_cvt_pk_bf16_f32 v22, v188, v189
    v_cvt_pk_bf16_f32 v23, v190, v191
    s_nop 1
    v_permlane32_swap_b32 v16, v18
    v_permlane32_swap_b32 v17, v19
    v_permlane32_swap_b32 v20, v22
    v_permlane32_swap_b32 v21, v23
    buffer_store_dwordx4 v[16:19], v12, s[52:55], 0 offen offset:0
    buffer_store_dwordx4 v[20:23], v12, s[52:55], 0 offen offset:32
    s_endpgm
La_exit:
    s_endpgm
.section .rodata,"a"
.p2align 6
.amdhsa_kernel gated_mix__ssm_conv_s4d__dense_activation_squared_relu__prompt_kernel
  .amdhsa_next_free_vgpr 256
  .amdhsa_next_free_sgpr 102
  .amdhsa_accum_offset 256
  .amdhsa_group_segment_fixed_size 0
  .amdhsa_kernarg_size 128
  .amdhsa_user_sgpr_count 2
  .amdhsa_user_sgpr_kernarg_segment_ptr 1
  .amdhsa_system_sgpr_workgroup_id_x 1
.end_amdhsa_kernel
```
